```python
import torch

def _softmax(x, axis=-1):
    return torch.softmax(x, dim=axis)

def _gelu(x):
    return torch.nn.functional.gelu(x, approximate='tanh')

def _silu(x):
    return torch.nn.functional.silu(x)

def _sigmoid(x):
    return torch.sigmoid(x)

def _layernorm(x, axis=-1, eps=1e-05):
    m = x.mean(dim=axis, keepdim=True)
    v = x.var(dim=axis, keepdim=True, unbiased=False)
    return (x - m) / torch.sqrt(v + eps)

def _scatter_add(tgt, idx, src, axis=0):
    return tgt.clone().index_add_(axis, idx, src)

def _segment_sum(src, seg, n):
    out = torch.zeros((n,) + src.shape[1:], dtype=src.dtype)
    return out.index_add_(0, seg, src)

def _pad(x, pw):
    flat = tuple((v for pair in reversed(pw) for v in pair))
    return torch.nn.functional.pad(x, flat)
kernel_name = 'adaLN_cond__mha_block_cached__glu_gated_geglu__decode'

def setup_inputs():

    _w = lambda a: (lambda t: t.to(torch.bfloat16) if t.is_floating_point() else t)(torch.as_tensor(a))

    def _A_setup():
        B, Sq, D = (1, 1, 640)
        H, Sk, Dh = (32, 32768, 192)
        return {'x': _w((lambda *s: torch.randn(*s, dtype=torch.bfloat16) * 0.05)(B, Sq, D)), 'k_cache': _w((lambda *s: torch.randn(*s, dtype=torch.bfloat16) * 0.8)(B, H, Sk, Dh)), 'v_cache': _w((lambda *s: torch.randn(*s, dtype=torch.bfloat16) * 3.2)(B, H, Sk, Dh)), 'wq': _w((lambda *s: torch.randn(*s, dtype=torch.bfloat16) * 0.8)(D, H * Dh) * D ** (-0.5)), 'wo': _w((lambda *s: torch.randn(*s, dtype=torch.bfloat16) * 3.2)(H * Dh, D) * (H * Dh) ** (-0.5))}
    _A_in = _A_setup()

    def _B_setup():
        B, S, Dm, Df = (1, 1, 640, 1536)
        return {'x': _w((lambda *s: torch.randn(*s, dtype=torch.bfloat16) * 0.05)(B, S, Dm)), 'w_gate': _w((lambda *s: torch.randn(*s, dtype=torch.bfloat16) * 3.2)(Dm, Df) * Dm ** (-0.5)), 'w_up': _w((lambda *s: torch.randn(*s, dtype=torch.bfloat16) * 3.2)(Dm, Df) * Dm ** (-0.5)), 'w_down': _w((lambda *s: torch.randn(*s, dtype=torch.bfloat16) * 3.2)(Df, Dm) * Df ** (-0.5))}
    _B_in = _B_setup()
    return {'A_x': _A_in['x'], 'A_k_cache': _A_in['k_cache'], 'A_v_cache': _A_in['v_cache'], 'A_wq': _A_in['wq'], 'A_wo': _A_in['wo'], 'B_x': _B_in['x'], 'B_w_gate': _B_in['w_gate'], 'B_w_up': _B_in['w_up'], 'B_w_down': _B_in['w_down'], 'c': _w((lambda *s: torch.randn(*s, dtype=torch.bfloat16) * 0.4)(1, 640) * 8.0), 'w_mod': _w((lambda *s: torch.randn(*s, dtype=torch.bfloat16) * 0.4)(640, 6 * 640) * 640 ** (-0.5) * 8.0)}

def reference(A_x, A_k_cache, A_v_cache, A_wq, A_wo, B_x, B_w_gate, B_w_up, B_w_down, c, w_mod):

    def _A_ref(x, k_cache, v_cache, wq, wo):
        B, Sq, D = x.shape
        H, Dh = (32, 192)
        q = (lambda x, *d: x.permute(*d))((x @ wq).reshape(B, Sq, H, Dh), 0, 2, 1, 3)
        scores = torch.einsum('bhqd,bhkd->bhqk', q, k_cache) * Dh ** (-0.5)
        p = _softmax(scores, axis=-1)
        o = torch.einsum('bhqk,bhkd->bhqd', p, v_cache)
        return (lambda x, *d: x.permute(*d))(o, 0, 2, 1, 3).reshape(B, Sq, H * Dh) @ wo

    def _B_ref(x, w_gate, w_up, w_down):
        g = torch.einsum('bsd,df->bsf', x, w_gate)
        u = torch.einsum('bsd,df->bsf', x, w_up)
        h = _gelu(g) * u
        return torch.einsum('bsf,fd->bsd', h, w_down)
    x = A_x
    mod = (_silu(c) @ w_mod).reshape(c.shape[0], 6, 1, -1)
    sa, ca, ga, sb, cb, gb = (mod[:, 0].clone(), mod[:, 1].clone(), mod[:, 2].clone(), mod[:, 3].clone(), mod[:, 4].clone(), mod[:, 5].clone())
    h = _layernorm(x, axis=-1) * (1 + ca) + sa
    x = x + ga * _A_ref(h, A_k_cache, A_v_cache, A_wq, A_wo)
    h = _layernorm(x, axis=-1) * (1 + cb) + sb
    x = x + gb * _B_ref(h, B_w_gate, B_w_up, B_w_down)
    return x
```

```asm
; @launch grid=(256,1,1) block=(256,1,1) lds=57344
.amdgcn_target "amdgcn-amd-amdhsa--gfx950"
.text
.globl adaLN_cond__mha_block_cached__glu_gated_geglu__decode_kernel
.p2align 8
.type adaLN_cond__mha_block_cached__glu_gated_geglu__decode_kernel,@function
adaLN_cond__mha_block_cached__glu_gated_geglu__decode_kernel:
    s_cmp_ge_u32 s2, 256
    s_cbranch_scc1 L_done
    s_load_dwordx16 s[16:31], s[0:1], 0
    s_load_dwordx8 s[32:39], s[0:1], 64
    s_load_dwordx2 s[42:43], s[0:1], 104
    v_lshrrev_b32 v1, 6, v0
    s_nop 0
    v_readfirstlane_b32 s3, v1
    v_and_b32 v0, 63, v0
    v_lshrrev_b32 v1, 3, v0
    v_and_b32 v2, 7, v0
    v_mul_u32_u24 v3, 384, v1
    v_lshl_add_u32 v3, v2, 4, v3
    s_lshr_b32 s68, s2, 3
    s_and_b32 s69, s2, 7
    s_and_b32 s76, s2, 3
    s_mul_i32 s76, s76, 160
    s_mul_i32 s77, s3, 40
    s_add_u32 s76, s76, s77
    s_lshl_b32 s78, s76, 1
    v_lshlrev_b32 v44, 1, v1
    s_mul_i32 s76, s76, 7680
    s_lshr_b32 s77, s2, 2
    s_lshl_b32 s77, s77, 7
    s_add_u32 s76, s76, s77
    v_mul_u32_u24 v45, 7680, v1
    v_lshl_add_u32 v45, v2, 4, v45
    s_cmp_ge_u32 s68, 24
    s_cbranch_scc1 L_ix1
    s_cmp_ge_u32 s68, 12
    s_cselect_b32 s84, 1, 0
    s_cselect_b32 s79, 12, 0
    s_sub_u32 s11, s68, s79
    s_lshl1_add_u32 s84, s69, s84
    s_mov_b32 s41, 12
    s_mov_b32 s82, 2048
    s_mov_b32 s86, s11
    s_branch L_ix3
L_ix1:
    s_sub_u32 s11, s68, 24
    s_cmp_ge_u32 s69, 5
    s_cbranch_scc1 L_ix2
    s_add_u32 s84, s69, 16
    s_mov_b32 s41, 8
    s_mov_b32 s82, 1366
    s_mov_b32 s86, s11
    s_branch L_ix3
L_ix2:
    s_lshr_b32 s84, s11, 2
    s_lshl1_add_u32 s84, s69, s84
    s_add_u32 s84, s84, 6
    s_and_b32 s11, s11, 3
    s_mov_b32 s41, 4
    s_cmp_eq_u32 s84, 21
    s_cselect_b32 s86, 0, 8
    s_add_u32 s86, s86, s11
    s_cmp_eq_u32 s84, 21
    s_cselect_b32 s79, 0, 1366
    s_add_u32 s11, s11, s79
    s_mov_b32 s82, 2048
    s_cmp_eq_u32 s84, 21
    s_cselect_b32 s82, 682, s82
L_ix3:
    s_mul_i32 s79, s41, 170
    s_add_u32 s79, s79, s11
    s_cmp_lt_u32 s79, s82
    s_cselect_b32 s82, 1, 0
    s_add_u32 s82, s82, 170
    s_mul_i32 s79, s84, 12
    s_add_u32 s86, s86, s79
    s_lshl_b32 s79, s84, 11
    s_add_u32 s11, s11, s79
    s_mov_b32 s8, s3
    s_mul_i32 s73, s8, s41
    s_add_u32 s73, s73, s11
    s_mul_i32 s73, s73, 6144
    s_mov_b32 s58, 1280
    s_mov_b32 s59, 0x20000
    s_mov_b32 s62, 4915200
    s_mov_b32 s63, 0x20000
    s_mov_b32 s46, 402653184
    s_mov_b32 s47, 0x20000
    s_mov_b32 s50, 402653184
    s_mov_b32 s51, 0x20000
    s_cmp_ge_u32 s2, 240
    s_waitcnt lgkmcnt(0)
    s_mov_b32 s56, s34
    s_mov_b32 s57, s35
    s_mov_b32 s60, s36
    s_mov_b32 s61, s37
    s_mov_b32 s44, s18
    s_mov_b32 s45, s19
    s_mov_b32 s48, s20
    s_mov_b32 s49, s21
    s_cbranch_scc1 L_noMload
    buffer_load_ushort v52, v44, s[56:59], s78 offen offset:0
    buffer_load_ushort v53, v44, s[56:59], s78 offen offset:16
    buffer_load_ushort v54, v44, s[56:59], s78 offen offset:32
    buffer_load_ushort v55, v44, s[56:59], s78 offen offset:48
    buffer_load_ushort v56, v44, s[56:59], s78 offen offset:64
    buffer_load_dwordx4 a[144:147], v45, s[60:63], s76 offen nt
    s_add_u32 s76, s76, 61440
    buffer_load_dwordx4 a[148:151], v45, s[60:63], s76 offen nt
    s_add_u32 s76, s76, 61440
    buffer_load_dwordx4 a[152:155], v45, s[60:63], s76 offen nt
    s_add_u32 s76, s76, 61440
    buffer_load_dwordx4 a[156:159], v45, s[60:63], s76 offen nt
    s_add_u32 s76, s76, 61440
    buffer_load_dwordx4 a[160:163], v45, s[60:63], s76 offen nt
L_noMload:
    s_load_dword s94, s[42:43], 0
    s_cmp_eq_u32 s3, 3
    s_cbranch_scc1 L_chain
    buffer_load_dwordx4 v[96:99], v3, s[44:47], s73 offen offset:0 nt
    buffer_load_dwordx4 v[100:103], v3, s[44:47], s73 offen offset:128 nt
    buffer_load_dwordx4 v[104:107], v3, s[44:47], s73 offen offset:256 nt
    buffer_load_dwordx4 v[108:111], v3, s[44:47], s73 offen offset:3072 nt
    buffer_load_dwordx4 v[112:115], v3, s[44:47], s73 offen offset:3200 nt
    buffer_load_dwordx4 v[116:119], v3, s[44:47], s73 offen offset:3328 nt
    buffer_load_dwordx4 a[0:3], v3, s[48:51], s73 offen offset:0 nt
    buffer_load_dwordx4 a[4:7], v3, s[48:51], s73 offen offset:128 nt
    buffer_load_dwordx4 a[8:11], v3, s[48:51], s73 offen offset:256 nt
    buffer_load_dwordx4 a[12:15], v3, s[48:51], s73 offen offset:3072 nt
    buffer_load_dwordx4 a[16:19], v3, s[48:51], s73 offen offset:3200 nt
    buffer_load_dwordx4 a[20:23], v3, s[48:51], s73 offen offset:3328 nt
    s_mov_b32 s52, s42
    s_mov_b32 s53, s43
    s_mov_b32 s54, 2818048
    s_mov_b32 s55, 0x20000
    v_and_b32 v44, 1, v2
    v_lshlrev_b32 v44, 4, v44
    v_mov_b32 v45, 0xffff
    v_lshlrev_b32 v45, v44, v45
    v_lshrrev_b32 v44, 1, v2
    v_cmp_eq_u32 vcc, 0, v44
    s_nop 1
    v_cndmask_b32 v4, 0, v45, vcc
    v_cmp_eq_u32 vcc, 1, v44
    s_nop 1
    v_cndmask_b32 v5, 0, v45, vcc
    v_cmp_eq_u32 vcc, 2, v44
    s_nop 1
    v_cndmask_b32 v6, 0, v45, vcc
    v_cmp_eq_u32 vcc, 3, v44
    s_nop 1
    v_cndmask_b32 v7, 0, v45, vcc
    v_mov_b32 v8, 0xff
    v_mov_b32 v9, 0x3fb8aa3b
    v_mov_b32 v93, 1
    v_mov_b32 v94, 12736
    s_mul_i32 s76, s68, 11
    s_lshr_b32 s76, s76, 5
    s_mul_i32 s77, s76, 3
    s_sub_u32 s77, s68, s77
    s_add_u32 s76, s76, 1
    s_cmp_ge_u32 s68, 30
    s_cselect_b32 s76, 0, s76
    s_cselect_b32 s93, 682, 0
    s_add_u32 s85, s76, 21
    s_mul_i32 s87, s76, 24
    s_lshl3_add_u32 s77, s77, s69
    s_add_u32 s87, s87, s77
    s_mul_i32 s76, s85, 4352
    s_add_u32 s76, s76, 851968
    s_add_u32 s12, s42, s76
    s_addc_u32 s13, s43, 0
    s_lshl2_add_u32 s76, s69, s68
    s_and_b32 s76, s76, 31
    s_mov_b32 s70, 1
    s_mov_b32 s88, s69
    s_mov_b32 s89, s76
    s_cmp_lt_u32 s76, 10
    s_cbranch_scc1 L_ro1
    s_mov_b32 s70, 2
    s_mul_i32 s88, s69, 6
    s_add_u32 s88, s88, s76
    s_sub_u32 s88, s88, 10
    s_cmp_lt_u32 s76, 16
    s_cbranch_scc1 L_ro1
    s_sub_u32 s89, s76, 16
    s_cmp_lt_u32 s69, 3
    s_cbranch_scc0 L_rr1
    s_add_u32 s88, s69, 8
    s_cmp_lt_u32 s89, 10
    s_cselect_b32 s70, 1, 0
    s_branch L_ro1
L_rr1:
    s_sub_u32 s88, s69, 3
    s_lshl1_add_u32 s88, s88, s89
    s_cmp_lt_u32 s89, 2
    s_cselect_b32 s70, 3, 0
L_ro1:
    s_sub_u32 s76, s70, 1
    s_cmp_lt_u32 s76, 2
    s_cselect_b32 s10, 20, 0x7fffffff
    s_cselect_b32 s81, 0, 4
    s_waitcnt lgkmcnt(0)
    s_add_u32 s94, s94, 0x9e3779b9
    s_bfe_u32 s64, s94, 0x80000
    s_bfe_u32 s65, s94, 0x80008
    s_bfe_u32 s66, s94, 0x80010
    s_bfe_u32 s67, s94, 0x80018
    s_cmp_ge_u32 s2, 240
    s_cbranch_scc1 L_noM2
    s_waitcnt vmcnt(17)
    v_lshlrev_b32 v52, 16, v52
    v_lshlrev_b32 v53, 16, v53
    v_lshlrev_b32 v54, 16, v54
    v_lshlrev_b32 v55, 16, v55
    v_lshlrev_b32 v56, 16, v56
    v_mul_f32 v44, 0xbfb8aa3b, v52
    v_mul_f32 v45, 0xbfb8aa3b, v53
    v_mul_f32 v46, 0xbfb8aa3b, v54
    v_mul_f32 v47, 0xbfb8aa3b, v55
    v_mul_f32 v48, 0xbfb8aa3b, v56
    v_exp_f32 v44, v44
    v_exp_f32 v45, v45
    v_exp_f32 v46, v46
    v_exp_f32 v47, v47
    v_exp_f32 v48, v48
    v_add_f32 v44, 1.0, v44
    v_add_f32 v45, 1.0, v45
    v_add_f32 v46, 1.0, v46
    v_add_f32 v47, 1.0, v47
    v_add_f32 v48, 1.0, v48
    v_rcp_f32 v44, v44
    v_rcp_f32 v45, v45
    v_rcp_f32 v46, v46
    v_rcp_f32 v47, v47
    v_rcp_f32 v48, v48
    v_mul_f32 v52, v52, v44
    v_mul_f32 v53, v53, v45
    v_mul_f32 v54, v54, v46
    v_mul_f32 v55, v55, v47
    v_mul_f32 v56, v56, v48
    v_cvt_pk_bf16_f32 v52, v52, v52
    v_cvt_pk_bf16_f32 v53, v53, v53
    v_cvt_pk_bf16_f32 v54, v54, v54
    v_cvt_pk_bf16_f32 v55, v55, v55
    v_cvt_pk_bf16_f32 v56, v56, v56
    v_lshlrev_b32 v44, 4, v0
    s_lshl_b32 s76, s3, 10
    v_add_u32 v44, s76, v44
    s_waitcnt vmcnt(12)
    v_and_b32 v36, v4, v52
    v_and_b32 v37, v5, v52
    v_and_b32 v38, v6, v52
    v_and_b32 v39, v7, v52
    v_and_b32 v40, v4, v53
    v_and_b32 v41, v5, v53
    v_and_b32 v42, v6, v53
    v_and_b32 v43, v7, v53
    v_mfma_f32_16x16x32_bf16 v[24:27], v[36:39], a[144:147], 0
    v_and_b32 v36, v4, v54
    v_and_b32 v37, v5, v54
    v_and_b32 v38, v6, v54
    v_and_b32 v39, v7, v54
    v_mfma_f32_16x16x32_bf16 v[24:27], v[40:43], a[148:151], v[24:27]
    v_and_b32 v40, v4, v55
    v_and_b32 v41, v5, v55
    v_and_b32 v42, v6, v55
    v_and_b32 v43, v7, v55
    v_mfma_f32_16x16x32_bf16 v[24:27], v[36:39], a[152:155], v[24:27]
    v_and_b32 v36, v4, v56
    v_and_b32 v37, v5, v56
    v_and_b32 v38, v6, v56
    v_and_b32 v39, v7, v56
    v_mfma_f32_16x16x32_bf16 v[24:27], v[40:43], a[156:159], v[24:27]
    s_nop 0
    v_mfma_f32_16x16x32_bf16 v[24:27], v[36:39], a[160:163], v[24:27]
    s_nop 7
    ds_write_b128 v44, v[24:27] offset:0
L_noM2:
    s_waitcnt lgkmcnt(0)
    s_barrier
    s_barrier
    s_mov_b64 exec, 1
    ds_add_rtn_u32 v92, v94, v93
    s_mov_b64 exec, -1
    s_waitcnt lgkmcnt(0)
    v_readfirstlane_b32 s8, v92
    s_nop 0
    s_mul_i32 s73, s8, s41
    s_add_u32 s73, s73, s11
    s_mul_i32 s73, s73, 6144
    s_waitcnt vmcnt(8)
    buffer_load_dwordx4 v[120:123], v3, s[44:47], s73 offen offset:0 nt
    s_waitcnt vmcnt(8)
    buffer_load_dwordx4 v[124:127], v3, s[44:47], s73 offen offset:128 nt
    s_waitcnt vmcnt(8)
    buffer_load_dwordx4 v[128:131], v3, s[44:47], s73 offen offset:256 nt
    s_waitcnt vmcnt(8)
    buffer_load_dwordx4 v[132:135], v3, s[44:47], s73 offen offset:3072 nt
    s_waitcnt vmcnt(8)
    buffer_load_dwordx4 v[136:139], v3, s[44:47], s73 offen offset:3200 nt
    s_waitcnt vmcnt(8)
    buffer_load_dwordx4 v[140:143], v3, s[44:47], s73 offen offset:3328 nt
    s_waitcnt vmcnt(8)
    buffer_load_dwordx4 a[24:27], v3, s[48:51], s73 offen offset:0 nt
    s_waitcnt vmcnt(8)
    buffer_load_dwordx4 a[28:31], v3, s[48:51], s73 offen offset:128 nt
    s_waitcnt vmcnt(8)
    buffer_load_dwordx4 a[32:35], v3, s[48:51], s73 offen offset:256 nt
    s_waitcnt vmcnt(8)
    buffer_load_dwordx4 a[36:39], v3, s[48:51], s73 offen offset:3072 nt
    s_waitcnt vmcnt(8)
    buffer_load_dwordx4 a[40:43], v3, s[48:51], s73 offen offset:3200 nt
    s_waitcnt vmcnt(8)
    buffer_load_dwordx4 a[44:47], v3, s[48:51], s73 offen offset:3328 nt
    ds_read_b32 v44, v94 offset:4
    s_waitcnt vmcnt(8) lgkmcnt(0)
    v_cmp_ne_u32 vcc, 0, v44
    s_mov_b32 s6, 0
    s_cbranch_vccnz L_enter
    s_mov_b64 exec, 1
    ds_add_rtn_u32 v92, v94, v93
    s_mov_b64 exec, -1
    s_waitcnt lgkmcnt(0)
    v_readfirstlane_b32 s8, v92
    s_nop 0
    s_mul_i32 s73, s8, s41
    s_add_u32 s73, s73, s11
    s_mul_i32 s73, s73, 6144
    s_waitcnt vmcnt(8)
    buffer_load_dwordx4 v[144:147], v3, s[44:47], s73 offen offset:0 nt
    s_waitcnt vmcnt(8)
    buffer_load_dwordx4 v[148:151], v3, s[44:47], s73 offen offset:128 nt
    s_waitcnt vmcnt(8)
    buffer_load_dwordx4 v[152:155], v3, s[44:47], s73 offen offset:256 nt
    s_waitcnt vmcnt(8)
    buffer_load_dwordx4 v[156:159], v3, s[44:47], s73 offen offset:3072 nt
    s_waitcnt vmcnt(8)
    buffer_load_dwordx4 v[160:163], v3, s[44:47], s73 offen offset:3200 nt
    s_waitcnt vmcnt(8)
    buffer_load_dwordx4 v[164:167], v3, s[44:47], s73 offen offset:3328 nt
    s_waitcnt vmcnt(8)
    buffer_load_dwordx4 a[48:51], v3, s[48:51], s73 offen offset:0 nt
    s_waitcnt vmcnt(8)
    buffer_load_dwordx4 a[52:55], v3, s[48:51], s73 offen offset:128 nt
    s_waitcnt vmcnt(8)
    buffer_load_dwordx4 a[56:59], v3, s[48:51], s73 offen offset:256 nt
    s_waitcnt vmcnt(8)
    buffer_load_dwordx4 a[60:63], v3, s[48:51], s73 offen offset:3072 nt
    s_waitcnt vmcnt(8)
    buffer_load_dwordx4 a[64:67], v3, s[48:51], s73 offen offset:3200 nt
    s_waitcnt vmcnt(8)
    buffer_load_dwordx4 a[68:71], v3, s[48:51], s73 offen offset:3328 nt
    ds_read_b32 v44, v94 offset:4
    s_waitcnt vmcnt(8) lgkmcnt(0)
    v_cmp_ne_u32 vcc, 0, v44
    s_mov_b32 s6, 1
    s_cbranch_vccnz L_enter
    s_mov_b64 exec, 1
    ds_add_rtn_u32 v92, v94, v93
    s_mov_b64 exec, -1
    s_waitcnt lgkmcnt(0)
    v_readfirstlane_b32 s8, v92
    s_nop 0
    s_mul_i32 s73, s8, s41
    s_add_u32 s73, s73, s11
    s_mul_i32 s73, s73, 6144
    s_waitcnt vmcnt(8)
    buffer_load_dwordx4 v[168:171], v3, s[44:47], s73 offen offset:0 nt
    s_waitcnt vmcnt(8)
    buffer_load_dwordx4 v[172:175], v3, s[44:47], s73 offen offset:128 nt
    s_waitcnt vmcnt(8)
    buffer_load_dwordx4 v[176:179], v3, s[44:47], s73 offen offset:256 nt
    s_waitcnt vmcnt(8)
    buffer_load_dwordx4 v[180:183], v3, s[44:47], s73 offen offset:3072 nt
    s_waitcnt vmcnt(8)
    buffer_load_dwordx4 v[184:187], v3, s[44:47], s73 offen offset:3200 nt
    s_waitcnt vmcnt(8)
    buffer_load_dwordx4 v[188:191], v3, s[44:47], s73 offen offset:3328 nt
    s_waitcnt vmcnt(8)
    buffer_load_dwordx4 a[72:75], v3, s[48:51], s73 offen offset:0 nt
    s_waitcnt vmcnt(8)
    buffer_load_dwordx4 a[76:79], v3, s[48:51], s73 offen offset:128 nt
    s_waitcnt vmcnt(8)
    buffer_load_dwordx4 a[80:83], v3, s[48:51], s73 offen offset:256 nt
    s_waitcnt vmcnt(8)
    buffer_load_dwordx4 a[84:87], v3, s[48:51], s73 offen offset:3072 nt
    s_waitcnt vmcnt(8)
    buffer_load_dwordx4 a[88:91], v3, s[48:51], s73 offen offset:3200 nt
    s_waitcnt vmcnt(8)
    buffer_load_dwordx4 a[92:95], v3, s[48:51], s73 offen offset:3328 nt
    ds_read_b32 v44, v94 offset:4
    s_waitcnt vmcnt(8) lgkmcnt(0)
    v_cmp_ne_u32 vcc, 0, v44
    s_mov_b32 s6, 2
    s_cbranch_vccnz L_enter
    s_mov_b64 exec, 1
    ds_add_rtn_u32 v92, v94, v93
    s_mov_b64 exec, -1
    s_waitcnt lgkmcnt(0)
    v_readfirstlane_b32 s8, v92
    s_nop 0
    s_mul_i32 s73, s8, s41
    s_add_u32 s73, s73, s11
    s_mul_i32 s73, s73, 6144
    s_waitcnt vmcnt(8)
    buffer_load_dwordx4 v[192:195], v3, s[44:47], s73 offen offset:0 nt
    s_waitcnt vmcnt(8)
    buffer_load_dwordx4 v[196:199], v3, s[44:47], s73 offen offset:128 nt
    s_waitcnt vmcnt(8)
    buffer_load_dwordx4 v[200:203], v3, s[44:47], s73 offen offset:256 nt
    s_waitcnt vmcnt(8)
    buffer_load_dwordx4 v[204:207], v3, s[44:47], s73 offen offset:3072 nt
    s_waitcnt vmcnt(8)
    buffer_load_dwordx4 v[208:211], v3, s[44:47], s73 offen offset:3200 nt
    s_waitcnt vmcnt(8)
    buffer_load_dwordx4 v[212:215], v3, s[44:47], s73 offen offset:3328 nt
    s_waitcnt vmcnt(8)
    buffer_load_dwordx4 a[96:99], v3, s[48:51], s73 offen offset:0 nt
    s_waitcnt vmcnt(8)
    buffer_load_dwordx4 a[100:103], v3, s[48:51], s73 offen offset:128 nt
    s_waitcnt vmcnt(8)
    buffer_load_dwordx4 a[104:107], v3, s[48:51], s73 offen offset:256 nt
    s_waitcnt vmcnt(8)
    buffer_load_dwordx4 a[108:111], v3, s[48:51], s73 offen offset:3072 nt
    s_waitcnt vmcnt(8)
    buffer_load_dwordx4 a[112:115], v3, s[48:51], s73 offen offset:3200 nt
    s_waitcnt vmcnt(8)
    buffer_load_dwordx4 a[116:119], v3, s[48:51], s73 offen offset:3328 nt
    ds_read_b32 v44, v94 offset:4
    s_waitcnt vmcnt(8) lgkmcnt(0)
    v_cmp_ne_u32 vcc, 0, v44
    s_mov_b32 s6, 3
    s_cbranch_vccnz L_enter
    s_mov_b64 exec, 1
    ds_add_rtn_u32 v92, v94, v93
    s_mov_b64 exec, -1
    s_waitcnt lgkmcnt(0)
    v_readfirstlane_b32 s8, v92
    s_nop 0
    s_mul_i32 s73, s8, s41
    s_add_u32 s73, s73, s11
    s_mul_i32 s73, s73, 6144
    s_waitcnt vmcnt(8)
    buffer_load_dwordx4 v[216:219], v3, s[44:47], s73 offen offset:0 nt
    s_waitcnt vmcnt(8)
    buffer_load_dwordx4 v[220:223], v3, s[44:47], s73 offen offset:128 nt
    s_waitcnt vmcnt(8)
    buffer_load_dwordx4 v[224:227], v3, s[44:47], s73 offen offset:256 nt
    s_waitcnt vmcnt(8)
    buffer_load_dwordx4 v[228:231], v3, s[44:47], s73 offen offset:3072 nt
    s_waitcnt vmcnt(8)
    buffer_load_dwordx4 v[232:235], v3, s[44:47], s73 offen offset:3200 nt
    s_waitcnt vmcnt(8)
    buffer_load_dwordx4 v[236:239], v3, s[44:47], s73 offen offset:3328 nt
    s_waitcnt vmcnt(8)
    buffer_load_dwordx4 a[120:123], v3, s[48:51], s73 offen offset:0 nt
    s_waitcnt vmcnt(8)
    buffer_load_dwordx4 a[124:127], v3, s[48:51], s73 offen offset:128 nt
    s_waitcnt vmcnt(8)
    buffer_load_dwordx4 a[128:131], v3, s[48:51], s73 offen offset:256 nt
    s_waitcnt vmcnt(8)
    buffer_load_dwordx4 a[132:135], v3, s[48:51], s73 offen offset:3072 nt
    s_waitcnt vmcnt(8)
    buffer_load_dwordx4 a[136:139], v3, s[48:51], s73 offen offset:3200 nt
    s_waitcnt vmcnt(8)
    buffer_load_dwordx4 a[140:143], v3, s[48:51], s73 offen offset:3328 nt
    s_mov_b32 s6, 4
    s_mov_b32 s75, 0
L_lf3:
    ds_read_b32 v44, v94 offset:4
    s_add_u32 s75, s75, 1
    s_cmp_gt_u32 s75, 16777216
    s_cbranch_scc1 L_done
    s_waitcnt lgkmcnt(0)
    v_cmp_ne_u32 vcc, 0, v44
    s_cbranch_vccz L_lf3
L_enter:
    s_cmp_eq_u32 s6, 0
    s_cselect_b32 s4, 0, 2
    s_waitcnt vmcnt(24)
    s_branch L_go
L_chain:
    s_mov_b32 s56, s16
    s_mov_b32 s57, s17
    s_mov_b32 s58, 1280
    s_mov_b32 s59, 0x20000
    s_mov_b32 s60, s22
    s_mov_b32 s61, s23
    s_mov_b32 s62, 7864320
    s_mov_b32 s63, 0x20000
    v_lshlrev_b32 v47, 4, v0
    buffer_load_dwordx4 v[60:63], v47, s[56:59], 0 offen
    buffer_load_dwordx4 v[64:67], v47, s[56:59], 0 offen offset:1024
    v_lshlrev_b32 v48, 3, v0
    s_mul_i32 s76, s69, 160
    buffer_load_dwordx2 v[68:69], v48, s[56:59], s76 offen
    s_mov_b32 s52, s42
    s_mov_b32 s53, s43
    s_mov_b32 s54, 2818048
    s_mov_b32 s55, 0x20000
    v_and_b32 v44, 1, v2
    v_lshlrev_b32 v44, 4, v44
    v_mov_b32 v45, 0xffff
    v_lshlrev_b32 v45, v44, v45
    v_lshrrev_b32 v44, 1, v2
    v_cmp_eq_u32 vcc, 0, v44
    s_nop 1
    v_cndmask_b32 v4, 0, v45, vcc
    v_cmp_eq_u32 vcc, 1, v44
    s_nop 1
    v_cndmask_b32 v5, 0, v45, vcc
    v_cmp_eq_u32 vcc, 2, v44
    s_nop 1
    v_cndmask_b32 v6, 0, v45, vcc
    v_cmp_eq_u32 vcc, 3, v44
    s_nop 1
    v_cndmask_b32 v7, 0, v45, vcc
    v_mov_b32 v8, 0xff
    v_mov_b32 v9, 0x3fb8aa3b
    v_mov_b32 v93, 1
    v_mov_b32 v94, 12736
    s_mul_i32 s76, s68, 11
    s_lshr_b32 s76, s76, 5
    s_mul_i32 s77, s76, 3
    s_sub_u32 s77, s68, s77
    s_add_u32 s76, s76, 1
    s_cmp_ge_u32 s68, 30
    s_cselect_b32 s76, 0, s76
    s_cselect_b32 s93, 682, 0
    s_add_u32 s85, s76, 21
    s_mul_i32 s87, s76, 24
    s_lshl3_add_u32 s77, s77, s69
    s_add_u32 s87, s87, s77
    s_mul_i32 s76, s85, 4352
    s_add_u32 s76, s76, 851968
    s_add_u32 s12, s42, s76
    s_addc_u32 s13, s43, 0
    s_lshl2_add_u32 s76, s69, s68
    s_and_b32 s76, s76, 31
    s_mov_b32 s70, 1
    s_mov_b32 s88, s69
    s_mov_b32 s89, s76
    s_cmp_lt_u32 s76, 10
    s_cbranch_scc1 L_ro4
    s_mov_b32 s70, 2
    s_mul_i32 s88, s69, 6
    s_add_u32 s88, s88, s76
    s_sub_u32 s88, s88, 10
    s_cmp_lt_u32 s76, 16
    s_cbranch_scc1 L_ro4
    s_sub_u32 s89, s76, 16
    s_cmp_lt_u32 s69, 3
    s_cbranch_scc0 L_rr4
    s_add_u32 s88, s69, 8
    s_cmp_lt_u32 s89, 10
    s_cselect_b32 s70, 1, 0
    s_branch L_ro4
L_rr4:
    s_sub_u32 s88, s69, 3
    s_lshl1_add_u32 s88, s88, s89
    s_cmp_lt_u32 s89, 2
    s_cselect_b32 s70, 3, 0
L_ro4:
    s_sub_u32 s76, s70, 1
    s_cmp_lt_u32 s76, 2
    s_cselect_b32 s10, 20, 0x7fffffff
    s_cselect_b32 s81, 0, 4
    s_waitcnt lgkmcnt(0)
    s_add_u32 s94, s94, 0x9e3779b9
    s_bfe_u32 s64, s94, 0x80000
    s_bfe_u32 s65, s94, 0x80008
    s_bfe_u32 s66, s94, 0x80010
    s_bfe_u32 s67, s94, 0x80018
    v_mov_b32 v48, 0
    v_mov_b32 v49, 0
    v_mov_b32 v50, 0
    v_mov_b32 v51, 0
    ds_write_b128 v47, v[48:51] offset:20480
    ds_write_b128 v47, v[48:51] offset:21504
    ds_write_b128 v47, v[48:51] offset:22528
    ds_write_b128 v47, v[48:51] offset:23552
    v_mov_b32 v72, 3
    v_mov_b32 v73, 0
    v_mov_b32 v74, 0
    v_mov_b32 v75, 0
    ds_write_b128 v94, v[72:75]
    s_cmp_ge_u32 s2, 240
    s_cbranch_scc1 L_noM5
    s_waitcnt vmcnt(8)
    v_lshlrev_b32 v52, 16, v52
    v_lshlrev_b32 v53, 16, v53
    v_lshlrev_b32 v54, 16, v54
    v_lshlrev_b32 v55, 16, v55
    v_lshlrev_b32 v56, 16, v56
    v_mul_f32 v44, 0xbfb8aa3b, v52
    v_mul_f32 v45, 0xbfb8aa3b, v53
    v_mul_f32 v46, 0xbfb8aa3b, v54
    v_mul_f32 v47, 0xbfb8aa3b, v55
    v_mul_f32 v48, 0xbfb8aa3b, v56
    v_exp_f32 v44, v44
    v_exp_f32 v45, v45
    v_exp_f32 v46, v46
    v_exp_f32 v47, v47
    v_exp_f32 v48, v48
    v_add_f32 v44, 1.0, v44
    v_add_f32 v45, 1.0, v45
    v_add_f32 v46, 1.0, v46
    v_add_f32 v47, 1.0, v47
    v_add_f32 v48, 1.0, v48
    v_rcp_f32 v44, v44
    v_rcp_f32 v45, v45
    v_rcp_f32 v46, v46
    v_rcp_f32 v47, v47
    v_rcp_f32 v48, v48
    v_mul_f32 v52, v52, v44
    v_mul_f32 v53, v53, v45
    v_mul_f32 v54, v54, v46
    v_mul_f32 v55, v55, v47
    v_mul_f32 v56, v56, v48
    v_cvt_pk_bf16_f32 v52, v52, v52
    v_cvt_pk_bf16_f32 v53, v53, v53
    v_cvt_pk_bf16_f32 v54, v54, v54
    v_cvt_pk_bf16_f32 v55, v55, v55
    v_cvt_pk_bf16_f32 v56, v56, v56
    v_lshlrev_b32 v44, 4, v0
    s_lshl_b32 s76, s3, 10
    v_add_u32 v44, s76, v44
    s_waitcnt vmcnt(3)
    v_and_b32 v36, v4, v52
    v_and_b32 v37, v5, v52
    v_and_b32 v38, v6, v52
    v_and_b32 v39, v7, v52
    v_and_b32 v40, v4, v53
    v_and_b32 v41, v5, v53
    v_and_b32 v42, v6, v53
    v_and_b32 v43, v7, v53
    v_mfma_f32_16x16x32_bf16 v[24:27], v[36:39], a[144:147], 0
    v_and_b32 v36, v4, v54
    v_and_b32 v37, v5, v54
    v_and_b32 v38, v6, v54
    v_and_b32 v39, v7, v54
    v_mfma_f32_16x16x32_bf16 v[24:27], v[40:43], a[148:151], v[24:27]
    v_and_b32 v40, v4, v55
    v_and_b32 v41, v5, v55
    v_and_b32 v42, v6, v55
    v_and_b32 v43, v7, v55
    v_mfma_f32_16x16x32_bf16 v[24:27], v[36:39], a[152:155], v[24:27]
    v_and_b32 v36, v4, v56
    v_and_b32 v37, v5, v56
    v_and_b32 v38, v6, v56
    v_and_b32 v39, v7, v56
    v_mfma_f32_16x16x32_bf16 v[24:27], v[40:43], a[156:159], v[24:27]
    s_nop 0
    v_mfma_f32_16x16x32_bf16 v[24:27], v[36:39], a[160:163], v[24:27]
    s_nop 7
    ds_write_b128 v44, v[24:27] offset:0
L_noM5:
    s_waitcnt lgkmcnt(0)
    s_barrier
    s_cmp_ge_u32 s2, 240
    s_cbranch_scc1 L_noMpub
    v_and_b32 v44, 1, v0
    v_bfe_u32 v45, v0, 1, 3
    v_lshlrev_b32 v45, 4, v45
    v_lshl_add_u32 v44, v44, 8, v45
    v_lshlrev_b32 v47, 4, v0
    s_and_b32 s76, s2, 3
    s_mul_i32 s76, s76, 15360
    s_lshr_b32 s77, s2, 2
    s_lshl_b32 s77, s77, 8
    s_add_u32 s76, s76, s77
    s_add_u32 s76, s76, 4096
    ds_read_b128 v[208:211], v44 offset:0
    ds_read_b128 v[212:215], v44 offset:640
    ds_read_b128 v[216:219], v44 offset:1024
    ds_read_b128 v[220:223], v44 offset:1664
    ds_read_b128 v[224:227], v44 offset:2048
    ds_read_b128 v[228:231], v44 offset:2688
    ds_read_b128 v[232:235], v44 offset:3072
    ds_read_b128 v[236:239], v44 offset:3712
    s_waitcnt lgkmcnt(6)
    v_pk_add_f32 v[208:209], v[208:209], v[212:213]
    v_pk_add_f32 v[210:211], v[210:211], v[214:215]
    s_waitcnt lgkmcnt(4)
    v_pk_add_f32 v[216:217], v[216:217], v[220:221]
    v_pk_add_f32 v[218:219], v[218:219], v[222:223]
    s_waitcnt lgkmcnt(2)
    v_pk_add_f32 v[224:225], v[224:225], v[228:229]
    v_pk_add_f32 v[226:227], v[226:227], v[230:231]
    s_waitcnt lgkmcnt(0)
    v_pk_add_f32 v[232:233], v[232:233], v[236:237]
    v_pk_add_f32 v[234:235], v[234:235], v[238:239]
    v_pk_add_f32 v[208:209], v[208:209], v[216:217]
    v_pk_add_f32 v[210:211], v[210:211], v[218:219]
    v_pk_add_f32 v[224:225], v[224:225], v[232:233]
    v_pk_add_f32 v[226:227], v[226:227], v[234:235]
    v_pk_add_f32 v[48:49], v[208:209], v[224:225]
    v_pk_add_f32 v[50:51], v[210:211], v[226:227]
    v_bfi_b32 v48, v8, s64, v48
    v_bfi_b32 v49, v8, s65, v49
    v_bfi_b32 v50, v8, s66, v50
    v_bfi_b32 v51, v8, s67, v51
    s_mov_b64 exec, 0xffff
    buffer_store_dwordx4 v[48:51], v47, s[52:55], s76 offen sc1
    s_mov_b64 exec, -1
L_noMpub:
    s_barrier
    s_mul_i32 s76, s69, 983040
    s_mul_i32 s77, s68, 384
    s_add_u32 s76, s76, s77
    v_mul_u32_u24 v46, 12288, v1
    v_lshl_add_u32 v46, v2, 4, v46
    buffer_load_dwordx4 a[0:3], v46, s[60:63], s76 offen offset:0 nt
    buffer_load_dwordx4 a[4:7], v46, s[60:63], s76 offen offset:128 nt
    buffer_load_dwordx4 a[8:11], v46, s[60:63], s76 offen offset:256 nt
    s_add_u32 s76, s76, 98304
    buffer_load_dwordx4 a[12:15], v46, s[60:63], s76 offen offset:0 nt
    buffer_load_dwordx4 a[16:19], v46, s[60:63], s76 offen offset:128 nt
    buffer_load_dwordx4 a[20:23], v46, s[60:63], s76 offen offset:256 nt
    s_add_u32 s76, s76, 98304
    buffer_load_dwordx4 a[24:27], v46, s[60:63], s76 offen offset:0 nt
    buffer_load_dwordx4 a[28:31], v46, s[60:63], s76 offen offset:128 nt
    buffer_load_dwordx4 a[32:35], v46, s[60:63], s76 offen offset:256 nt
    s_add_u32 s76, s76, 98304
    buffer_load_dwordx4 a[36:39], v46, s[60:63], s76 offen offset:0 nt
    buffer_load_dwordx4 a[40:43], v46, s[60:63], s76 offen offset:128 nt
    buffer_load_dwordx4 a[44:47], v46, s[60:63], s76 offen offset:256 nt
    s_add_u32 s76, s76, 98304
    buffer_load_dwordx4 a[48:51], v46, s[60:63], s76 offen offset:0 nt
    buffer_load_dwordx4 a[52:55], v46, s[60:63], s76 offen offset:128 nt
    buffer_load_dwordx4 a[56:59], v46, s[60:63], s76 offen offset:256 nt
    s_add_u32 s76, s76, 98304
    buffer_load_dwordx4 a[60:63], v46, s[60:63], s76 offen offset:0 nt
    buffer_load_dwordx4 a[64:67], v46, s[60:63], s76 offen offset:128 nt
    buffer_load_dwordx4 a[68:71], v46, s[60:63], s76 offen offset:256 nt
    s_add_u32 s76, s76, 98304
    buffer_load_dwordx4 a[72:75], v46, s[60:63], s76 offen offset:0 nt
    buffer_load_dwordx4 a[76:79], v46, s[60:63], s76 offen offset:128 nt
    buffer_load_dwordx4 a[80:83], v46, s[60:63], s76 offen offset:256 nt
    s_add_u32 s76, s76, 98304
    buffer_load_dwordx4 a[84:87], v46, s[60:63], s76 offen offset:0 nt
    buffer_load_dwordx4 a[88:91], v46, s[60:63], s76 offen offset:128 nt
    buffer_load_dwordx4 a[92:95], v46, s[60:63], s76 offen offset:256 nt
    s_add_u32 s76, s76, 98304
    buffer_load_dwordx4 a[96:99], v46, s[60:63], s76 offen offset:0 nt
    buffer_load_dwordx4 a[100:103], v46, s[60:63], s76 offen offset:128 nt
    buffer_load_dwordx4 a[104:107], v46, s[60:63], s76 offen offset:256 nt
    s_add_u32 s76, s76, 98304
    buffer_load_dwordx4 a[108:111], v46, s[60:63], s76 offen offset:0 nt
    buffer_load_dwordx4 a[112:115], v46, s[60:63], s76 offen offset:128 nt
    buffer_load_dwordx4 a[116:119], v46, s[60:63], s76 offen offset:256 nt
    s_cmp_lg_u32 s69, 0
    s_cbranch_scc1 L_nocnt
    s_mul_i32 s76, s68, 4352
    s_add_u32 s76, s76, 851968
    v_mov_b32 v44, 0
    s_mov_b64 exec, 1
    buffer_store_dword v44, v44, s[52:55], s76 offen sc1
    s_mov_b64 exec, -1
L_nocnt:
    s_waitcnt vmcnt(30)
    v_lshlrev_b32 v208, 16, v60
    v_and_b32 v209, 0xffff0000, v60
    v_lshlrev_b32 v210, 16, v61
    v_and_b32 v211, 0xffff0000, v61
    v_lshlrev_b32 v212, 16, v62
    v_and_b32 v213, 0xffff0000, v62
    v_lshlrev_b32 v214, 16, v63
    v_and_b32 v215, 0xffff0000, v63
    v_lshlrev_b32 v216, 16, v64
    v_and_b32 v217, 0xffff0000, v64
    v_lshlrev_b32 v218, 16, v65
    v_and_b32 v219, 0xffff0000, v65
    v_lshlrev_b32 v220, 16, v66
    v_and_b32 v221, 0xffff0000, v66
    v_lshlrev_b32 v222, 16, v67
    v_and_b32 v223, 0xffff0000, v67
    v_pk_add_f32 v[52:53], v[208:209], v[212:213]
    v_pk_add_f32 v[54:55], v[210:211], v[214:215]
    v_pk_add_f32 v[52:53], v[52:53], v[216:217]
    v_pk_add_f32 v[54:55], v[54:55], v[218:219]
    v_pk_add_f32 v[52:53], v[52:53], v[220:221]
    v_pk_add_f32 v[54:55], v[54:55], v[222:223]
    v_add_f32 v52, v52, v53
    v_add_f32 v54, v54, v55
    v_add_f32 v52, v52, v54
    s_nop 1
    v_add_f32_dpp v52, v52, v52 quad_perm:[1,0,3,2] row_mask:0xf bank_mask:0xf
    s_nop 1
    v_add_f32_dpp v52, v52, v52 quad_perm:[2,3,0,1] row_mask:0xf bank_mask:0xf
    s_nop 1
    v_add_f32_dpp v52, v52, v52 row_half_mirror row_mask:0xf bank_mask:0xf
    s_nop 1
    v_add_f32_dpp v52, v52, v52 row_ror:8 row_mask:0xf bank_mask:0xf
    v_mov_b32 v53, v52
    s_nop 1
    v_permlane16_swap_b32 v52, v53
    v_add_f32 v52, v52, v53
    v_mov_b32 v53, v52
    s_nop 1
    v_permlane32_swap_b32 v52, v53
    v_add_f32 v52, v52, v53
    v_mul_f32 v52, 0x3acccccd, v52
    v_pk_add_f32 v[208:209], v[208:209], v[52:53] op_sel:[0,0] op_sel_hi:[1,0] neg_lo:[0,1] neg_hi:[0,1]
    v_pk_add_f32 v[210:211], v[210:211], v[52:53] op_sel:[0,0] op_sel_hi:[1,0] neg_lo:[0,1] neg_hi:[0,1]
    v_pk_add_f32 v[212:213], v[212:213], v[52:53] op_sel:[0,0] op_sel_hi:[1,0] neg_lo:[0,1] neg_hi:[0,1]
    v_pk_add_f32 v[214:215], v[214:215], v[52:53] op_sel:[0,0] op_sel_hi:[1,0] neg_lo:[0,1] neg_hi:[0,1]
    v_pk_add_f32 v[216:217], v[216:217], v[52:53] op_sel:[0,0] op_sel_hi:[1,0] neg_lo:[0,1] neg_hi:[0,1]
    v_pk_add_f32 v[218:219], v[218:219], v[52:53] op_sel:[0,0] op_sel_hi:[1,0] neg_lo:[0,1] neg_hi:[0,1]
    v_pk_add_f32 v[220:221], v[220:221], v[52:53] op_sel:[0,0] op_sel_hi:[1,0] neg_lo:[0,1] neg_hi:[0,1]
    v_pk_add_f32 v[222:223], v[222:223], v[52:53] op_sel:[0,0] op_sel_hi:[1,0] neg_lo:[0,1] neg_hi:[0,1]
    v_mul_f32 v54, v208, v208
    v_fmac_f32 v54, v209, v209
    v_fmac_f32 v54, v210, v210
    v_fmac_f32 v54, v211, v211
    v_fmac_f32 v54, v212, v212
    v_fmac_f32 v54, v213, v213
    v_fmac_f32 v54, v214, v214
    v_fmac_f32 v54, v215, v215
    s_mov_b64 exec, 0xffff
    v_fmac_f32 v54, v216, v216
    v_fmac_f32 v54, v217, v217
    v_fmac_f32 v54, v218, v218
    v_fmac_f32 v54, v219, v219
    v_fmac_f32 v54, v220, v220
    v_fmac_f32 v54, v221, v221
    v_fmac_f32 v54, v222, v222
    v_fmac_f32 v54, v223, v223
    s_mov_b64 exec, -1
    s_nop 0
    v_add_f32_dpp v54, v54, v54 quad_perm:[1,0,3,2] row_mask:0xf bank_mask:0xf
    s_nop 1
    v_add_f32_dpp v54, v54, v54 quad_perm:[2,3,0,1] row_mask:0xf bank_mask:0xf
    s_nop 1
    v_add_f32_dpp v54, v54, v54 row_half_mirror row_mask:0xf bank_mask:0xf
    s_nop 1
    v_add_f32_dpp v54, v54, v54 row_ror:8 row_mask:0xf bank_mask:0xf
    v_mov_b32 v53, v54
    s_nop 1
    v_permlane16_swap_b32 v54, v53
    v_add_f32 v54, v54, v53
    v_mov_b32 v53, v54
    s_nop 1
    v_permlane32_swap_b32 v54, v53
    v_add_f32 v54, v54, v53
    v_mul_f32 v54, 0x3acccccd, v54
    v_cvt_pk_bf16_f32 v54, v54, v54
    v_lshlrev_b32 v54, 16, v54
    v_cvt_pk_bf16_f32 v52, v52, v52
    v_lshlrev_b32 v52, 16, v52
    v_add_f32 v54, 0x3727c5ac, v54
    v_cvt_pk_bf16_f32 v54, v54, v54
    v_lshlrev_b32 v54, 16, v54
    v_sqrt_f32 v54, v54
    s_nop 0
    v_cvt_pk_bf16_f32 v54, v54, v54
    v_lshlrev_b32 v54, 16, v54
    v_rcp_f32 v54, v54
    v_lshlrev_b32 v56, 16, v68
    v_and_b32 v57, 0xffff0000, v68
    v_lshlrev_b32 v58, 16, v69
    v_and_b32 v59, 0xffff0000, v69
    v_pk_add_f32 v[56:57], v[56:57], v[52:53] op_sel:[0,0] op_sel_hi:[1,0] neg_lo:[0,1] neg_hi:[0,1]
    v_pk_add_f32 v[58:59], v[58:59], v[52:53] op_sel:[0,0] op_sel_hi:[1,0] neg_lo:[0,1] neg_hi:[0,1]
    v_cvt_pk_bf16_f32 v44, v56, v57
    v_cvt_pk_bf16_f32 v45, v58, v59
    v_lshlrev_b32 v56, 16, v44
    v_and_b32 v57, 0xffff0000, v44
    v_lshlrev_b32 v58, 16, v45
    v_and_b32 v59, 0xffff0000, v45
    v_pk_mul_f32 v[56:57], v[56:57], v[54:55] op_sel:[0,0] op_sel_hi:[1,0]
    v_pk_mul_f32 v[58:59], v[58:59], v[54:55] op_sel:[0,0] op_sel_hi:[1,0]
    v_cvt_pk_bf16_f32 v44, v56, v57
    v_cvt_pk_bf16_f32 v45, v58, v59
    v_lshlrev_b32 v56, 16, v44
    v_and_b32 v57, 0xffff0000, v44
    v_lshlrev_b32 v58, 16, v45
    v_and_b32 v59, 0xffff0000, v45
    v_and_b32 v46, 31, v0
    v_lshrrev_b32 v47, 5, v0
    v_mul_u32_u24 v47, 2560, v47
    v_lshl_add_u32 v46, v46, 4, v47
    s_mul_i32 s76, s69, 320
    s_add_u32 s76, s76, 4096
    s_add_u32 s77, s76, 15360
    s_add_u32 s78, s77, 15360
    s_add_u32 s79, s78, 15360
    s_mov_b32 exec_lo, 0xfffff
    s_mov_b32 exec_hi, 0xfffff
    s_mov_b32 s75, 0
L_poll6:
    buffer_load_dwordx4 v[208:211], v46, s[52:55], s76 offen sc1
    buffer_load_dwordx4 v[212:215], v46, s[52:55], s77 offen sc1
    buffer_load_dwordx4 v[216:219], v46, s[52:55], s78 offen sc1
    buffer_load_dwordx4 v[220:223], v46, s[52:55], s79 offen sc1
    s_add_u32 s75, s75, 1
    s_cmp_gt_u32 s75, 2097152
    s_cbranch_scc1 L_done
    s_waitcnt vmcnt(3)
    v_xor_b32 v208, s64, v208
    v_xor_b32 v209, s65, v209
    v_xor_b32 v210, s66, v210
    v_xor_b32 v211, s67, v211
    v_or3_b32 v47, v208, v209, v210
    v_or_b32 v47, v47, v211
    s_waitcnt vmcnt(2)
    v_xor_b32 v212, s64, v212
    v_xor_b32 v213, s65, v213
    v_xor_b32 v214, s66, v214
    v_xor_b32 v215, s67, v215
    v_or3_b32 v47, v212, v213, v47
    v_or3_b32 v47, v214, v215, v47
    s_waitcnt vmcnt(1)
    v_xor_b32 v216, s64, v216
    v_xor_b32 v217, s65, v217
    v_xor_b32 v218, s66, v218
    v_xor_b32 v219, s67, v219
    v_or3_b32 v47, v216, v217, v47
    v_or3_b32 v47, v218, v219, v47
    s_waitcnt vmcnt(0)
    v_xor_b32 v220, s64, v220
    v_xor_b32 v221, s65, v221
    v_xor_b32 v222, s66, v222
    v_xor_b32 v223, s67, v223
    v_or3_b32 v47, v220, v221, v47
    v_or3_b32 v47, v222, v223, v47
    v_and_b32 v47, v8, v47
    v_cmp_ne_u32 vcc, 0, v47
    s_cbranch_vccnz L_poll6
    s_mov_b64 exec, -1
    v_pk_add_f32 v[208:209], v[208:209], v[212:213]
    v_pk_add_f32 v[210:211], v[210:211], v[214:215]
    v_pk_add_f32 v[216:217], v[216:217], v[220:221]
    v_pk_add_f32 v[218:219], v[218:219], v[222:223]
    v_pk_add_f32 v[48:49], v[208:209], v[216:217]
    v_pk_add_f32 v[50:51], v[210:211], v[218:219]
    v_cvt_pk_bf16_f32 v44, v48, v49
    v_cvt_pk_bf16_f32 v45, v50, v51
    v_lshlrev_b32 v48, 16, v44
    v_and_b32 v49, 0xffff0000, v44
    v_lshlrev_b32 v50, 16, v45
    v_and_b32 v51, 0xffff0000, v45
    v_add_f32 v60, 1.0, v48
    v_add_f32 v61, 1.0, v49
    v_add_f32 v62, 1.0, v50
    v_add_f32 v63, 1.0, v51
    v_cvt_pk_bf16_f32 v44, v60, v61
    v_cvt_pk_bf16_f32 v45, v62, v63
    v_lshlrev_b32 v60, 16, v44
    v_and_b32 v61, 0xffff0000, v44
    v_lshlrev_b32 v62, 16, v45
    v_and_b32 v63, 0xffff0000, v45
    v_mov_b32 v64, v60
    v_mov_b32 v65, v61
    v_mov_b32 v66, v62
    v_mov_b32 v67, v63
    v_lshlrev_b32 v47, 4, v0
    v_lshlrev_b32 v46, 2, v1
    v_permlane32_swap_b32 v64, v60
    v_permlane32_swap_b32 v65, v61
    v_permlane32_swap_b32 v66, v62
    v_permlane32_swap_b32 v67, v63
    v_pk_mul_f32 v[56:57], v[56:57], v[60:61]
    v_pk_mul_f32 v[58:59], v[58:59], v[62:63]
    v_cvt_pk_bf16_f32 v44, v56, v57
    v_cvt_pk_bf16_f32 v45, v58, v59
    v_lshlrev_b32 v56, 16, v44
    v_and_b32 v57, 0xffff0000, v44
    v_lshlrev_b32 v58, 16, v45
    v_and_b32 v59, 0xffff0000, v45
    v_pk_add_f32 v[56:57], v[56:57], v[48:49]
    v_pk_add_f32 v[58:59], v[58:59], v[50:51]
    v_cvt_pk_bf16_f32 v56, v56, v56
    v_cvt_pk_bf16_f32 v57, v57, v57
    v_cvt_pk_bf16_f32 v58, v58, v58
    v_cvt_pk_bf16_f32 v59, v59, v59
    s_mov_b64 exec, 0xfffff
    ds_write_b128 v47, v[56:59] offset:12352
    s_mov_b64 exec, -1
    s_waitcnt lgkmcnt(0)
    ds_read_b32 v208, v46 offset:12352
    ds_read_b32 v209, v46 offset:12384
    ds_read_b32 v210, v46 offset:12416
    ds_read_b32 v211, v46 offset:12448
    ds_read_b32 v212, v46 offset:12480
    ds_read_b32 v213, v46 offset:12512
    ds_read_b32 v214, v46 offset:12544
    ds_read_b32 v215, v46 offset:12576
    ds_read_b32 v216, v46 offset:12608
    ds_read_b32 v217, v46 offset:12640
    v_lshrrev_b32 v44, 4, v0
    v_lshl_add_u32 v44, v2, 1, v44
    v_lshlrev_b32 v44, 4, v44
    s_lshl_b32 s76, s2, 10
    s_add_u32 s76, s76, 131072
    s_waitcnt lgkmcnt(0)
    v_and_b32 v36, v4, v208
    v_and_b32 v37, v5, v208
    v_and_b32 v38, v6, v208
    v_and_b32 v39, v7, v208
    v_and_b32 v40, v4, v209
    v_and_b32 v41, v5, v209
    v_and_b32 v42, v6, v209
    v_and_b32 v43, v7, v209
    v_mfma_f32_16x16x32_bf16 v[24:27], v[36:39], a[0:3], 0
    v_mfma_f32_16x16x32_bf16 v[28:31], v[36:39], a[4:7], 0
    v_mfma_f32_16x16x32_bf16 v[32:35], v[36:39], a[8:11], 0
    v_and_b32 v36, v4, v210
    v_and_b32 v37, v5, v210
    v_and_b32 v38, v6, v210
    v_and_b32 v39, v7, v210
    v_mfma_f32_16x16x32_bf16 v[24:27], v[40:43], a[12:15], v[24:27]
    v_mfma_f32_16x16x32_bf16 v[28:31], v[40:43], a[16:19], v[28:31]
    v_mfma_f32_16x16x32_bf16 v[32:35], v[40:43], a[20:23], v[32:35]
    v_and_b32 v40, v4, v211
    v_and_b32 v41, v5, v211
    v_and_b32 v42, v6, v211
    v_and_b32 v43, v7, v211
    v_mfma_f32_16x16x32_bf16 v[24:27], v[36:39], a[24:27], v[24:27]
    v_mfma_f32_16x16x32_bf16 v[28:31], v[36:39], a[28:31], v[28:31]
    v_mfma_f32_16x16x32_bf16 v[32:35], v[36:39], a[32:35], v[32:35]
    v_and_b32 v36, v4, v212
    v_and_b32 v37, v5, v212
    v_and_b32 v38, v6, v212
    v_and_b32 v39, v7, v212
    v_mfma_f32_16x16x32_bf16 v[24:27], v[40:43], a[36:39], v[24:27]
    v_mfma_f32_16x16x32_bf16 v[28:31], v[40:43], a[40:43], v[28:31]
    v_mfma_f32_16x16x32_bf16 v[32:35], v[40:43], a[44:47], v[32:35]
    v_and_b32 v40, v4, v213
    v_and_b32 v41, v5, v213
    v_and_b32 v42, v6, v213
    v_and_b32 v43, v7, v213
    v_mfma_f32_16x16x32_bf16 v[24:27], v[36:39], a[48:51], v[24:27]
    v_mfma_f32_16x16x32_bf16 v[28:31], v[36:39], a[52:55], v[28:31]
    v_mfma_f32_16x16x32_bf16 v[32:35], v[36:39], a[56:59], v[32:35]
    v_and_b32 v36, v4, v214
    v_and_b32 v37, v5, v214
    v_and_b32 v38, v6, v214
    v_and_b32 v39, v7, v214
    v_mfma_f32_16x16x32_bf16 v[24:27], v[40:43], a[60:63], v[24:27]
    v_mfma_f32_16x16x32_bf16 v[28:31], v[40:43], a[64:67], v[28:31]
    v_mfma_f32_16x16x32_bf16 v[32:35], v[40:43], a[68:71], v[32:35]
    v_and_b32 v40, v4, v215
    v_and_b32 v41, v5, v215
    v_and_b32 v42, v6, v215
    v_and_b32 v43, v7, v215
    v_mfma_f32_16x16x32_bf16 v[24:27], v[36:39], a[72:75], v[24:27]
    v_mfma_f32_16x16x32_bf16 v[28:31], v[36:39], a[76:79], v[28:31]
    v_mfma_f32_16x16x32_bf16 v[32:35], v[36:39], a[80:83], v[32:35]
    v_and_b32 v36, v4, v216
    v_and_b32 v37, v5, v216
    v_and_b32 v38, v6, v216
    v_and_b32 v39, v7, v216
    v_mfma_f32_16x16x32_bf16 v[24:27], v[40:43], a[84:87], v[24:27]
    v_mfma_f32_16x16x32_bf16 v[28:31], v[40:43], a[88:91], v[28:31]
    v_mfma_f32_16x16x32_bf16 v[32:35], v[40:43], a[92:95], v[32:35]
    v_and_b32 v40, v4, v217
    v_and_b32 v41, v5, v217
    v_and_b32 v42, v6, v217
    v_and_b32 v43, v7, v217
    v_mfma_f32_16x16x32_bf16 v[24:27], v[36:39], a[96:99], v[24:27]
    v_mfma_f32_16x16x32_bf16 v[28:31], v[36:39], a[100:103], v[28:31]
    v_mfma_f32_16x16x32_bf16 v[32:35], v[36:39], a[104:107], v[32:35]
    v_mfma_f32_16x16x32_bf16 v[24:27], v[40:43], a[108:111], v[24:27]
    v_mfma_f32_16x16x32_bf16 v[28:31], v[40:43], a[112:115], v[28:31]
    v_mfma_f32_16x16x32_bf16 v[32:35], v[40:43], a[116:119], v[32:35]
    s_nop 5
    v_mov_b32 v220, v24
    v_mov_b32 v221, v25
    v_mov_b32 v222, v26
    v_mov_b32 v223, v27
    v_mov_b32 v224, v28
    v_mov_b32 v225, v29
    v_mov_b32 v226, v30
    v_mov_b32 v227, v31
    v_mov_b32 v228, v32
    v_mov_b32 v229, v33
    v_mov_b32 v230, v34
    v_mov_b32 v231, v35
    v_permlane32_swap_b32 v24, v220
    v_permlane32_swap_b32 v25, v221
    v_permlane32_swap_b32 v26, v222
    v_permlane32_swap_b32 v27, v223
    v_permlane32_swap_b32 v28, v224
    v_permlane32_swap_b32 v29, v225
    v_permlane32_swap_b32 v30, v226
    v_permlane32_swap_b32 v31, v227
    v_permlane32_swap_b32 v32, v228
    v_permlane32_swap_b32 v33, v229
    v_permlane32_swap_b32 v34, v230
    v_permlane32_swap_b32 v35, v231
    v_add_f32_dpp v24, v220, v24 row_ror:8 row_mask:0xf bank_mask:0xf
    v_add_f32_dpp v25, v221, v25 row_ror:8 row_mask:0xf bank_mask:0xf
    v_add_f32_dpp v26, v222, v26 row_ror:8 row_mask:0xf bank_mask:0xf
    v_add_f32_dpp v27, v223, v27 row_ror:8 row_mask:0xf bank_mask:0xf
    v_add_f32_dpp v28, v224, v28 row_ror:8 row_mask:0xf bank_mask:0xf
    v_add_f32_dpp v29, v225, v29 row_ror:8 row_mask:0xf bank_mask:0xf
    v_add_f32_dpp v30, v226, v30 row_ror:8 row_mask:0xf bank_mask:0xf
    v_add_f32_dpp v31, v227, v31 row_ror:8 row_mask:0xf bank_mask:0xf
    v_add_f32_dpp v32, v228, v32 row_ror:8 row_mask:0xf bank_mask:0xf
    v_add_f32_dpp v33, v229, v33 row_ror:8 row_mask:0xf bank_mask:0xf
    v_add_f32_dpp v34, v230, v34 row_ror:8 row_mask:0xf bank_mask:0xf
    v_add_f32_dpp v35, v231, v35 row_ror:8 row_mask:0xf bank_mask:0xf
    v_bfi_b32 v24, v8, s64, v24
    v_bfi_b32 v25, v8, s65, v25
    v_bfi_b32 v26, v8, s66, v26
    v_bfi_b32 v27, v8, s67, v27
    v_bfi_b32 v28, v8, s64, v28
    v_bfi_b32 v29, v8, s65, v29
    v_bfi_b32 v30, v8, s66, v30
    v_bfi_b32 v31, v8, s67, v31
    v_bfi_b32 v32, v8, s64, v32
    v_bfi_b32 v33, v8, s65, v33
    v_bfi_b32 v34, v8, s66, v34
    v_bfi_b32 v35, v8, s67, v35
    s_mov_b64 exec, 0xff00ff
    buffer_store_dwordx4 v[24:27], v44, s[52:55], s76 offen offset:0 sc1
    buffer_store_dwordx4 v[28:31], v44, s[52:55], s76 offen offset:256 sc1
    buffer_store_dwordx4 v[32:35], v44, s[52:55], s76 offen offset:512 sc1
    s_mov_b32 s76, s84
    s_lshl_b32 s76, s76, 13
    s_add_u32 s76, s76, 131072
    s_add_u32 s77, s76, 4096
    s_mov_b32 exec_lo, 0xffffffff
    s_mov_b32 exec_hi, 0xffff
    s_mov_b32 s75, 0
L_poll7:
    buffer_load_dwordx4 v[208:211], v47, s[52:55], s76 offen offset:0 sc1
    buffer_load_dwordx4 v[212:215], v47, s[52:55], s76 offen offset:1024 sc1
    buffer_load_dwordx4 v[216:219], v47, s[52:55], s76 offen offset:2048 sc1
    buffer_load_dwordx4 v[220:223], v47, s[52:55], s76 offen offset:3072 sc1
    buffer_load_dwordx4 v[224:227], v47, s[52:55], s77 offen offset:0 sc1
    buffer_load_dwordx4 v[228:231], v47, s[52:55], s77 offen offset:1024 sc1
    buffer_load_dwordx4 v[232:235], v47, s[52:55], s77 offen offset:2048 sc1
    buffer_load_dwordx4 v[236:239], v47, s[52:55], s77 offen offset:3072 sc1
    s_add_u32 s75, s75, 1
    s_cmp_gt_u32 s75, 2097152
    s_cbranch_scc1 L_done
    s_waitcnt vmcnt(7)
    v_xor_b32 v208, s64, v208
    v_xor_b32 v209, s65, v209
    v_xor_b32 v210, s66, v210
    v_xor_b32 v211, s67, v211
    v_or3_b32 v46, v208, v209, v210
    v_or_b32 v46, v46, v211
    s_waitcnt vmcnt(6)
    v_xor_b32 v212, s64, v212
    v_xor_b32 v213, s65, v213
    v_xor_b32 v214, s66, v214
    v_xor_b32 v215, s67, v215
    v_or3_b32 v46, v212, v213, v46
    v_or3_b32 v46, v214, v215, v46
    s_waitcnt vmcnt(5)
    v_xor_b32 v216, s64, v216
    v_xor_b32 v217, s65, v217
    v_xor_b32 v218, s66, v218
    v_xor_b32 v219, s67, v219
    v_or3_b32 v46, v216, v217, v46
    v_or3_b32 v46, v218, v219, v46
    s_waitcnt vmcnt(4)
    v_xor_b32 v220, s64, v220
    v_xor_b32 v221, s65, v221
    v_xor_b32 v222, s66, v222
    v_xor_b32 v223, s67, v223
    v_or3_b32 v46, v220, v221, v46
    v_or3_b32 v46, v222, v223, v46
    s_waitcnt vmcnt(3)
    v_xor_b32 v224, s64, v224
    v_xor_b32 v225, s65, v225
    v_xor_b32 v226, s66, v226
    v_xor_b32 v227, s67, v227
    v_or3_b32 v46, v224, v225, v46
    v_or3_b32 v46, v226, v227, v46
    s_waitcnt vmcnt(2)
    v_xor_b32 v228, s64, v228
    v_xor_b32 v229, s65, v229
    v_xor_b32 v230, s66, v230
    v_xor_b32 v231, s67, v231
    v_or3_b32 v46, v228, v229, v46
    v_or3_b32 v46, v230, v231, v46
    s_waitcnt vmcnt(1)
    v_xor_b32 v232, s64, v232
    v_xor_b32 v233, s65, v233
    v_xor_b32 v234, s66, v234
    v_xor_b32 v235, s67, v235
    v_or3_b32 v46, v232, v233, v46
    v_or3_b32 v46, v234, v235, v46
    s_waitcnt vmcnt(0)
    v_xor_b32 v236, s64, v236
    v_xor_b32 v237, s65, v237
    v_xor_b32 v238, s66, v238
    v_xor_b32 v239, s67, v239
    v_or3_b32 v46, v236, v237, v46
    v_or3_b32 v46, v238, v239, v46
    v_and_b32 v46, v8, v46
    v_cmp_ne_u32 vcc, 0, v46
    s_cbranch_vccnz L_poll7
    v_pk_add_f32 v[208:209], v[208:209], v[212:213]
    v_pk_add_f32 v[210:211], v[210:211], v[214:215]
    v_pk_add_f32 v[216:217], v[216:217], v[220:221]
    v_pk_add_f32 v[218:219], v[218:219], v[222:223]
    v_pk_add_f32 v[224:225], v[224:225], v[228:229]
    v_pk_add_f32 v[226:227], v[226:227], v[230:231]
    v_pk_add_f32 v[232:233], v[232:233], v[236:237]
    v_pk_add_f32 v[234:235], v[234:235], v[238:239]
    v_pk_add_f32 v[208:209], v[208:209], v[216:217]
    v_pk_add_f32 v[210:211], v[210:211], v[218:219]
    v_pk_add_f32 v[224:225], v[224:225], v[232:233]
    v_pk_add_f32 v[226:227], v[226:227], v[234:235]
    v_pk_add_f32 v[48:49], v[208:209], v[224:225]
    v_pk_add_f32 v[50:51], v[210:211], v[226:227]
    v_cvt_pk_bf16_f32 v44, v48, v49
    v_cvt_pk_bf16_f32 v45, v50, v51
    v_lshlrev_b32 v46, 3, v0
    ds_write_b64 v46, v[44:45] offset:12800
    s_waitcnt lgkmcnt(0)
    s_mov_b64 exec, 1
    ds_write_b32 v94, v93 offset:4
    s_mov_b64 exec, -1
    s_mov_b64 exec, 1
    ds_add_rtn_u32 v92, v94, v93
    s_mov_b64 exec, -1
    s_waitcnt lgkmcnt(0)
    v_readfirstlane_b32 s8, v92
    s_nop 0
    s_mul_i32 s73, s8, s41
    s_add_u32 s73, s73, s11
    s_mul_i32 s73, s73, 6144
    buffer_load_dwordx4 v[96:99], v3, s[44:47], s73 offen offset:0 nt
    buffer_load_dwordx4 v[100:103], v3, s[44:47], s73 offen offset:128 nt
    buffer_load_dwordx4 v[104:107], v3, s[44:47], s73 offen offset:256 nt
    buffer_load_dwordx4 v[108:111], v3, s[44:47], s73 offen offset:3072 nt
    buffer_load_dwordx4 v[112:115], v3, s[44:47], s73 offen offset:3200 nt
    buffer_load_dwordx4 v[116:119], v3, s[44:47], s73 offen offset:3328 nt
    buffer_load_dwordx4 a[0:3], v3, s[48:51], s73 offen offset:0 nt
    buffer_load_dwordx4 a[4:7], v3, s[48:51], s73 offen offset:128 nt
    buffer_load_dwordx4 a[8:11], v3, s[48:51], s73 offen offset:256 nt
    buffer_load_dwordx4 a[12:15], v3, s[48:51], s73 offen offset:3072 nt
    buffer_load_dwordx4 a[16:19], v3, s[48:51], s73 offen offset:3200 nt
    buffer_load_dwordx4 a[20:23], v3, s[48:51], s73 offen offset:3328 nt
    s_mov_b64 exec, 1
    ds_add_rtn_u32 v92, v94, v93
    s_mov_b64 exec, -1
    s_waitcnt lgkmcnt(0)
    v_readfirstlane_b32 s8, v92
    s_nop 0
    s_mul_i32 s73, s8, s41
    s_add_u32 s73, s73, s11
    s_mul_i32 s73, s73, 6144
    buffer_load_dwordx4 v[120:123], v3, s[44:47], s73 offen offset:0 nt
    buffer_load_dwordx4 v[124:127], v3, s[44:47], s73 offen offset:128 nt
    buffer_load_dwordx4 v[128:131], v3, s[44:47], s73 offen offset:256 nt
    buffer_load_dwordx4 v[132:135], v3, s[44:47], s73 offen offset:3072 nt
    buffer_load_dwordx4 v[136:139], v3, s[44:47], s73 offen offset:3200 nt
    buffer_load_dwordx4 v[140:143], v3, s[44:47], s73 offen offset:3328 nt
    buffer_load_dwordx4 a[24:27], v3, s[48:51], s73 offen offset:0 nt
    buffer_load_dwordx4 a[28:31], v3, s[48:51], s73 offen offset:128 nt
    buffer_load_dwordx4 a[32:35], v3, s[48:51], s73 offen offset:256 nt
    buffer_load_dwordx4 a[36:39], v3, s[48:51], s73 offen offset:3072 nt
    buffer_load_dwordx4 a[40:43], v3, s[48:51], s73 offen offset:3200 nt
    buffer_load_dwordx4 a[44:47], v3, s[48:51], s73 offen offset:3328 nt
    s_mov_b32 s76, s85
    s_lshl_b32 s76, s76, 13
    s_add_u32 s76, s76, 131072
    s_add_u32 s77, s76, 4096
    s_mov_b32 exec_lo, 0xffffffff
    s_mov_b32 exec_hi, 0xffff
    s_mov_b32 s75, 0
L_poll8:
    buffer_load_dwordx4 v[208:211], v47, s[52:55], s76 offen offset:0 sc1
    buffer_load_dwordx4 v[212:215], v47, s[52:55], s76 offen offset:1024 sc1
    buffer_load_dwordx4 v[216:219], v47, s[52:55], s76 offen offset:2048 sc1
    buffer_load_dwordx4 v[220:223], v47, s[52:55], s76 offen offset:3072 sc1
    buffer_load_dwordx4 v[224:227], v47, s[52:55], s77 offen offset:0 sc1
    buffer_load_dwordx4 v[228:231], v47, s[52:55], s77 offen offset:1024 sc1
    buffer_load_dwordx4 v[232:235], v47, s[52:55], s77 offen offset:2048 sc1
    buffer_load_dwordx4 v[236:239], v47, s[52:55], s77 offen offset:3072 sc1
    s_add_u32 s75, s75, 1
    s_cmp_gt_u32 s75, 2097152
    s_cbranch_scc1 L_done
    s_waitcnt vmcnt(7)
    v_xor_b32 v208, s64, v208
    v_xor_b32 v209, s65, v209
    v_xor_b32 v210, s66, v210
    v_xor_b32 v211, s67, v211
    v_or3_b32 v46, v208, v209, v210
    v_or_b32 v46, v46, v211
    s_waitcnt vmcnt(6)
    v_xor_b32 v212, s64, v212
    v_xor_b32 v213, s65, v213
    v_xor_b32 v214, s66, v214
    v_xor_b32 v215, s67, v215
    v_or3_b32 v46, v212, v213, v46
    v_or3_b32 v46, v214, v215, v46
    s_waitcnt vmcnt(5)
    v_xor_b32 v216, s64, v216
    v_xor_b32 v217, s65, v217
    v_xor_b32 v218, s66, v218
    v_xor_b32 v219, s67, v219
    v_or3_b32 v46, v216, v217, v46
    v_or3_b32 v46, v218, v219, v46
    s_waitcnt vmcnt(4)
    v_xor_b32 v220, s64, v220
    v_xor_b32 v221, s65, v221
    v_xor_b32 v222, s66, v222
    v_xor_b32 v223, s67, v223
    v_or3_b32 v46, v220, v221, v46
    v_or3_b32 v46, v222, v223, v46
    s_waitcnt vmcnt(3)
    v_xor_b32 v224, s64, v224
    v_xor_b32 v225, s65, v225
    v_xor_b32 v226, s66, v226
    v_xor_b32 v227, s67, v227
    v_or3_b32 v46, v224, v225, v46
    v_or3_b32 v46, v226, v227, v46
    s_waitcnt vmcnt(2)
    v_xor_b32 v228, s64, v228
    v_xor_b32 v229, s65, v229
    v_xor_b32 v230, s66, v230
    v_xor_b32 v231, s67, v231
    v_or3_b32 v46, v228, v229, v46
    v_or3_b32 v46, v230, v231, v46
    s_waitcnt vmcnt(1)
    v_xor_b32 v232, s64, v232
    v_xor_b32 v233, s65, v233
    v_xor_b32 v234, s66, v234
    v_xor_b32 v235, s67, v235
    v_or3_b32 v46, v232, v233, v46
    v_or3_b32 v46, v234, v235, v46
    s_waitcnt vmcnt(0)
    v_xor_b32 v236, s64, v236
    v_xor_b32 v237, s65, v237
    v_xor_b32 v238, s66, v238
    v_xor_b32 v239, s67, v239
    v_or3_b32 v46, v236, v237, v46
    v_or3_b32 v46, v238, v239, v46
    v_and_b32 v46, v8, v46
    v_cmp_ne_u32 vcc, 0, v46
    s_cbranch_vccnz L_poll8
    v_pk_add_f32 v[208:209], v[208:209], v[212:213]
    v_pk_add_f32 v[210:211], v[210:211], v[214:215]
    v_pk_add_f32 v[216:217], v[216:217], v[220:221]
    v_pk_add_f32 v[218:219], v[218:219], v[222:223]
    v_pk_add_f32 v[224:225], v[224:225], v[228:229]
    v_pk_add_f32 v[226:227], v[226:227], v[230:231]
    v_pk_add_f32 v[232:233], v[232:233], v[236:237]
    v_pk_add_f32 v[234:235], v[234:235], v[238:239]
    v_pk_add_f32 v[208:209], v[208:209], v[216:217]
    v_pk_add_f32 v[210:211], v[210:211], v[218:219]
    v_pk_add_f32 v[224:225], v[224:225], v[232:233]
    v_pk_add_f32 v[226:227], v[226:227], v[234:235]
    v_pk_add_f32 v[48:49], v[208:209], v[224:225]
    v_pk_add_f32 v[50:51], v[210:211], v[226:227]
    v_cvt_pk_bf16_f32 v44, v48, v49
    v_cvt_pk_bf16_f32 v45, v50, v51
    v_lshlrev_b32 v46, 3, v0
    ds_write_b64 v46, v[44:45] offset:19968
    s_waitcnt lgkmcnt(0)
    s_mov_b64 exec, 1
    ds_write_b32 v94, v93 offset:8
    s_mov_b64 exec, -1
    s_mov_b32 s4, 0
    s_mov_b32 s6, 0
L_go:
    v_lshlrev_b32 v44, 4, v2
    ds_read_b128 v[12:15], v44 offset:12800
    ds_read_b128 v[16:19], v44 offset:12928
    ds_read_b128 v[20:23], v44 offset:13056
    v_mov_b32 v24, 0
    v_mov_b32 v25, 0
    v_mov_b32 v26, 0
    v_mov_b32 v27, 0
    v_mov_b32 v28, 0
    v_mov_b32 v29, 0
    v_mov_b32 v30, 0
    v_mov_b32 v31, 0
    v_mov_b32 v32, 0
    v_mov_b32 v33, 0
    v_mov_b32 v34, 0
    v_mov_b32 v35, 0
    v_mov_b32 v11, 0
    s_mov_b32 s71, 0xff800000
    s_mov_b32 s72, 0xff800000
    s_sub_u32 s83, s82, 6
    s_mov_b32 s74, 0
    s_mov_b32 s95, s93
    s_mov_b32 s0, 0x7fffffff
    s_mov_b32 s1, 0
    s_mov_b32 s5, s1
    s_mov_b32 s7, s1
    s_mov_b32 s4, s4
    s_mov_b32 s1, s1
    s_mov_b32 s70, s70
    s_waitcnt lgkmcnt(0)
L_loop:
    s_sub_u32 s0, s0, 1
    s_cbranch_scc1 L_sw0
L_sb0:
    s_waitcnt vmcnt(18)
    s_cmp_eq_u32 s4, 0
    s_cbranch_scc0 L_nd0
    s_mov_b64 exec, 1
    ds_add_rtn_u32 v92, v94, v93
    s_mov_b64 exec, -1
L_nd0:
    v_dot2_f32_bf16 v44, v96, v12, 0
    v_dot2_f32_bf16 v45, v108, v12, 0
    v_dot2_f32_bf16 v46, v97, v13, 0
    v_dot2_f32_bf16 v47, v109, v13, 0
    v_dot2_f32_bf16 v44, v98, v14, v44
    v_dot2_f32_bf16 v45, v110, v14, v45
    v_dot2_f32_bf16 v46, v99, v15, v46
    v_dot2_f32_bf16 v47, v111, v15, v47
    v_dot2_f32_bf16 v44, v100, v16, v44
    v_dot2_f32_bf16 v45, v112, v16, v45
    v_dot2_f32_bf16 v46, v101, v17, v46
    v_dot2_f32_bf16 v47, v113, v17, v47
    v_dot2_f32_bf16 v44, v102, v18, v44
    v_dot2_f32_bf16 v45, v114, v18, v45
    v_dot2_f32_bf16 v46, v103, v19, v46
    v_dot2_f32_bf16 v47, v115, v19, v47
    v_dot2_f32_bf16 v44, v104, v20, v44
    v_dot2_f32_bf16 v45, v116, v20, v45
    v_dot2_f32_bf16 v46, v105, v21, v46
    v_dot2_f32_bf16 v47, v117, v21, v47
    v_dot2_f32_bf16 v44, v106, v22, v44
    v_dot2_f32_bf16 v45, v118, v22, v45
    v_dot2_f32_bf16 v46, v107, v23, v46
    v_dot2_f32_bf16 v47, v119, v23, v47
    s_cmp_lg_u32 s4, 0
    s_cbranch_scc1 L_sp0
    s_waitcnt lgkmcnt(0)
    v_readfirstlane_b32 s8, v92
    s_mov_b32 s5, 1
    s_cmp_ge_u32 s8, s83
    s_cbranch_scc1 L_ck0
L_cb0:
    s_mul_i32 s73, s8, s41
    s_add_u32 s73, s73, s11
    s_mul_i32 s73, s73, 6144
    buffer_load_dwordx4 v[144:147], v3, s[44:47], s73 offen offset:0 nt
    buffer_load_dwordx4 v[148:151], v3, s[44:47], s73 offen offset:128 nt
    buffer_load_dwordx4 v[152:155], v3, s[44:47], s73 offen offset:256 nt
    buffer_load_dwordx4 v[156:159], v3, s[44:47], s73 offen offset:3072 nt
    buffer_load_dwordx4 v[160:163], v3, s[44:47], s73 offen offset:3200 nt
    buffer_load_dwordx4 v[164:167], v3, s[44:47], s73 offen offset:3328 nt
L_nk0:
    v_add_f32 v44, v44, v46
    v_add_f32 v45, v45, v47
    s_nop 0
    v_add_f32_dpp v44, v44, v44 quad_perm:[1,0,3,2] row_mask:0xf bank_mask:0xf
    v_add_f32_dpp v45, v45, v45 quad_perm:[1,0,3,2] row_mask:0xf bank_mask:0xf
    s_nop 0
    v_add_f32_dpp v44, v44, v44 quad_perm:[2,3,0,1] row_mask:0xf bank_mask:0xf
    v_add_f32_dpp v45, v45, v45 quad_perm:[2,3,0,1] row_mask:0xf bank_mask:0xf
    s_nop 0
    v_add_f32_dpp v44, v44, v44 row_half_mirror row_mask:0xf bank_mask:0xf
    v_add_f32_dpp v45, v45, v45 row_half_mirror row_mask:0xf bank_mask:0xf
    v_cvt_pk_bf16_f32 v46, v44, v45
    v_lshlrev_b32 v44, 16, v46
    v_and_b32 v45, 0xffff0000, v46
    v_mul_f32 v44, 0x3d93cd3a, v44
    v_mul_f32 v45, 0x3d93cd3a, v45
    v_cvt_pk_bf16_f32 v46, v44, v45
    v_lshlrev_b32 v44, 16, v46
    v_and_b32 v45, 0xffff0000, v46
    v_max_f32 v46, v44, v45
    v_cmp_lt_f32 vcc, s71, v46
    s_cbranch_vccnz L_slow0
L_back0:
    v_fma_f32 v44, v44, v9, -s72
    v_fma_f32 v45, v45, v9, -s72
    v_exp_f32 v44, v44
    v_exp_f32 v45, v45
    v_add_f32 v11, v11, v44
    v_cvt_pk_bf16_f32 v44, v44, v44
    v_add_f32 v11, v11, v45
    v_cvt_pk_bf16_f32 v45, v45, v45
    v_and_b32 v36, v4, v44
    v_and_b32 v37, v5, v44
    v_and_b32 v38, v6, v44
    v_and_b32 v39, v7, v44
    v_and_b32 v40, v4, v45
    v_and_b32 v41, v5, v45
    v_and_b32 v42, v6, v45
    v_and_b32 v43, v7, v45
    s_cmp_lg_u32 s5, 1
    s_cbranch_scc1 L_vs0
L_vb0:
    s_waitcnt vmcnt(18)
    v_mfma_f32_16x16x32_bf16 v[24:27], v[36:39], a[0:3], v[24:27]
    v_mfma_f32_16x16x32_bf16 v[28:31], v[36:39], a[4:7], v[28:31]
    v_mfma_f32_16x16x32_bf16 v[32:35], v[36:39], a[8:11], v[32:35]
    v_mfma_f32_16x16x32_bf16 v[24:27], v[40:43], a[12:15], v[24:27]
    v_mfma_f32_16x16x32_bf16 v[28:31], v[40:43], a[16:19], v[28:31]
    v_mfma_f32_16x16x32_bf16 v[32:35], v[40:43], a[20:23], v[32:35]
    buffer_load_dwordx4 a[48:51], v3, s[48:51], s73 offen offset:0 nt
    buffer_load_dwordx4 a[52:55], v3, s[48:51], s73 offen offset:128 nt
    buffer_load_dwordx4 a[56:59], v3, s[48:51], s73 offen offset:256 nt
    buffer_load_dwordx4 a[60:63], v3, s[48:51], s73 offen offset:3072 nt
    buffer_load_dwordx4 a[64:67], v3, s[48:51], s73 offen offset:3200 nt
    buffer_load_dwordx4 a[68:71], v3, s[48:51], s73 offen offset:3328 nt
    s_sub_u32 s10, s10, 1
    s_cbranch_scc1 L_wl0
L_nx0:
    s_sub_u32 s0, s0, 1
    s_cbranch_scc1 L_sw1
L_sb1:
    s_waitcnt vmcnt(18)
    s_cmp_eq_u32 s4, 0
    s_cbranch_scc0 L_nd1
    s_mov_b64 exec, 1
    ds_add_rtn_u32 v92, v94, v93
    s_mov_b64 exec, -1
L_nd1:
    v_dot2_f32_bf16 v44, v120, v12, 0
    v_dot2_f32_bf16 v45, v132, v12, 0
    v_dot2_f32_bf16 v46, v121, v13, 0
    v_dot2_f32_bf16 v47, v133, v13, 0
    v_dot2_f32_bf16 v44, v122, v14, v44
    v_dot2_f32_bf16 v45, v134, v14, v45
    v_dot2_f32_bf16 v46, v123, v15, v46
    v_dot2_f32_bf16 v47, v135, v15, v47
    v_dot2_f32_bf16 v44, v124, v16, v44
    v_dot2_f32_bf16 v45, v136, v16, v45
    v_dot2_f32_bf16 v46, v125, v17, v46
    v_dot2_f32_bf16 v47, v137, v17, v47
    v_dot2_f32_bf16 v44, v126, v18, v44
    v_dot2_f32_bf16 v45, v138, v18, v45
    v_dot2_f32_bf16 v46, v127, v19, v46
    v_dot2_f32_bf16 v47, v139, v19, v47
    v_dot2_f32_bf16 v44, v128, v20, v44
    v_dot2_f32_bf16 v45, v140, v20, v45
    v_dot2_f32_bf16 v46, v129, v21, v46
    v_dot2_f32_bf16 v47, v141, v21, v47
    v_dot2_f32_bf16 v44, v130, v22, v44
    v_dot2_f32_bf16 v45, v142, v22, v45
    v_dot2_f32_bf16 v46, v131, v23, v46
    v_dot2_f32_bf16 v47, v143, v23, v47
    s_cmp_lg_u32 s4, 0
    s_cbranch_scc1 L_sp1
    s_waitcnt lgkmcnt(0)
    v_readfirstlane_b32 s8, v92
    s_mov_b32 s5, 1
    s_cmp_ge_u32 s8, s83
    s_cbranch_scc1 L_ck1
L_cb1:
    s_mul_i32 s73, s8, s41
    s_add_u32 s73, s73, s11
    s_mul_i32 s73, s73, 6144
    buffer_load_dwordx4 v[168:171], v3, s[44:47], s73 offen offset:0 nt
    buffer_load_dwordx4 v[172:175], v3, s[44:47], s73 offen offset:128 nt
    buffer_load_dwordx4 v[176:179], v3, s[44:47], s73 offen offset:256 nt
    buffer_load_dwordx4 v[180:183], v3, s[44:47], s73 offen offset:3072 nt
    buffer_load_dwordx4 v[184:187], v3, s[44:47], s73 offen offset:3200 nt
    buffer_load_dwordx4 v[188:191], v3, s[44:47], s73 offen offset:3328 nt
L_nk1:
    v_add_f32 v44, v44, v46
    v_add_f32 v45, v45, v47
    s_nop 0
    v_add_f32_dpp v44, v44, v44 quad_perm:[1,0,3,2] row_mask:0xf bank_mask:0xf
    v_add_f32_dpp v45, v45, v45 quad_perm:[1,0,3,2] row_mask:0xf bank_mask:0xf
    s_nop 0
    v_add_f32_dpp v44, v44, v44 quad_perm:[2,3,0,1] row_mask:0xf bank_mask:0xf
    v_add_f32_dpp v45, v45, v45 quad_perm:[2,3,0,1] row_mask:0xf bank_mask:0xf
    s_nop 0
    v_add_f32_dpp v44, v44, v44 row_half_mirror row_mask:0xf bank_mask:0xf
    v_add_f32_dpp v45, v45, v45 row_half_mirror row_mask:0xf bank_mask:0xf
    v_cvt_pk_bf16_f32 v46, v44, v45
    v_lshlrev_b32 v44, 16, v46
    v_and_b32 v45, 0xffff0000, v46
    v_mul_f32 v44, 0x3d93cd3a, v44
    v_mul_f32 v45, 0x3d93cd3a, v45
    v_cvt_pk_bf16_f32 v46, v44, v45
    v_lshlrev_b32 v44, 16, v46
    v_and_b32 v45, 0xffff0000, v46
    v_max_f32 v46, v44, v45
    v_cmp_lt_f32 vcc, s71, v46
    s_cbranch_vccnz L_slow1
L_back1:
    v_fma_f32 v44, v44, v9, -s72
    v_fma_f32 v45, v45, v9, -s72
    v_exp_f32 v44, v44
    v_exp_f32 v45, v45
    v_add_f32 v11, v11, v44
    v_cvt_pk_bf16_f32 v44, v44, v44
    v_add_f32 v11, v11, v45
    v_cvt_pk_bf16_f32 v45, v45, v45
    v_and_b32 v36, v4, v44
    v_and_b32 v37, v5, v44
    v_and_b32 v38, v6, v44
    v_and_b32 v39, v7, v44
    v_and_b32 v40, v4, v45
    v_and_b32 v41, v5, v45
    v_and_b32 v42, v6, v45
    v_and_b32 v43, v7, v45
    s_cmp_lg_u32 s5, 1
    s_cbranch_scc1 L_vs1
L_vb1:
    s_waitcnt vmcnt(18)
    v_mfma_f32_16x16x32_bf16 v[24:27], v[36:39], a[24:27], v[24:27]
    v_mfma_f32_16x16x32_bf16 v[28:31], v[36:39], a[28:31], v[28:31]
    v_mfma_f32_16x16x32_bf16 v[32:35], v[36:39], a[32:35], v[32:35]
    v_mfma_f32_16x16x32_bf16 v[24:27], v[40:43], a[36:39], v[24:27]
    v_mfma_f32_16x16x32_bf16 v[28:31], v[40:43], a[40:43], v[28:31]
    v_mfma_f32_16x16x32_bf16 v[32:35], v[40:43], a[44:47], v[32:35]
    buffer_load_dwordx4 a[72:75], v3, s[48:51], s73 offen offset:0 nt
    buffer_load_dwordx4 a[76:79], v3, s[48:51], s73 offen offset:128 nt
    buffer_load_dwordx4 a[80:83], v3, s[48:51], s73 offen offset:256 nt
    buffer_load_dwordx4 a[84:87], v3, s[48:51], s73 offen offset:3072 nt
    buffer_load_dwordx4 a[88:91], v3, s[48:51], s73 offen offset:3200 nt
    buffer_load_dwordx4 a[92:95], v3, s[48:51], s73 offen offset:3328 nt
    s_sub_u32 s10, s10, 1
    s_cbranch_scc1 L_wl1
L_nx1:
    s_sub_u32 s0, s0, 1
    s_cbranch_scc1 L_sw2
L_sb2:
    s_waitcnt vmcnt(18)
    s_cmp_eq_u32 s4, 0
    s_cbranch_scc0 L_nd2
    s_mov_b64 exec, 1
    ds_add_rtn_u32 v92, v94, v93
    s_mov_b64 exec, -1
L_nd2:
    v_dot2_f32_bf16 v44, v144, v12, 0
    v_dot2_f32_bf16 v45, v156, v12, 0
    v_dot2_f32_bf16 v46, v145, v13, 0
    v_dot2_f32_bf16 v47, v157, v13, 0
    v_dot2_f32_bf16 v44, v146, v14, v44
    v_dot2_f32_bf16 v45, v158, v14, v45
    v_dot2_f32_bf16 v46, v147, v15, v46
    v_dot2_f32_bf16 v47, v159, v15, v47
    v_dot2_f32_bf16 v44, v148, v16, v44
    v_dot2_f32_bf16 v45, v160, v16, v45
    v_dot2_f32_bf16 v46, v149, v17, v46
    v_dot2_f32_bf16 v47, v161, v17, v47
    v_dot2_f32_bf16 v44, v150, v18, v44
    v_dot2_f32_bf16 v45, v162, v18, v45
    v_dot2_f32_bf16 v46, v151, v19, v46
    v_dot2_f32_bf16 v47, v163, v19, v47
    v_dot2_f32_bf16 v44, v152, v20, v44
    v_dot2_f32_bf16 v45, v164, v20, v45
    v_dot2_f32_bf16 v46, v153, v21, v46
    v_dot2_f32_bf16 v47, v165, v21, v47
    v_dot2_f32_bf16 v44, v154, v22, v44
    v_dot2_f32_bf16 v45, v166, v22, v45
    v_dot2_f32_bf16 v46, v155, v23, v46
    v_dot2_f32_bf16 v47, v167, v23, v47
    s_cmp_lg_u32 s4, 0
    s_cbranch_scc1 L_sp2
    s_waitcnt lgkmcnt(0)
    v_readfirstlane_b32 s8, v92
    s_mov_b32 s5, 1
    s_cmp_ge_u32 s8, s83
    s_cbranch_scc1 L_ck2
L_cb2:
    s_mul_i32 s73, s8, s41
    s_add_u32 s73, s73, s11
    s_mul_i32 s73, s73, 6144
    buffer_load_dwordx4 v[192:195], v3, s[44:47], s73 offen offset:0 nt
    buffer_load_dwordx4 v[196:199], v3, s[44:47], s73 offen offset:128 nt
    buffer_load_dwordx4 v[200:203], v3, s[44:47], s73 offen offset:256 nt
    buffer_load_dwordx4 v[204:207], v3, s[44:47], s73 offen offset:3072 nt
    buffer_load_dwordx4 v[208:211], v3, s[44:47], s73 offen offset:3200 nt
    buffer_load_dwordx4 v[212:215], v3, s[44:47], s73 offen offset:3328 nt
L_nk2:
    v_add_f32 v44, v44, v46
    v_add_f32 v45, v45, v47
    s_nop 0
    v_add_f32_dpp v44, v44, v44 quad_perm:[1,0,3,2] row_mask:0xf bank_mask:0xf
    v_add_f32_dpp v45, v45, v45 quad_perm:[1,0,3,2] row_mask:0xf bank_mask:0xf
    s_nop 0
    v_add_f32_dpp v44, v44, v44 quad_perm:[2,3,0,1] row_mask:0xf bank_mask:0xf
    v_add_f32_dpp v45, v45, v45 quad_perm:[2,3,0,1] row_mask:0xf bank_mask:0xf
    s_nop 0
    v_add_f32_dpp v44, v44, v44 row_half_mirror row_mask:0xf bank_mask:0xf
    v_add_f32_dpp v45, v45, v45 row_half_mirror row_mask:0xf bank_mask:0xf
    v_cvt_pk_bf16_f32 v46, v44, v45
    v_lshlrev_b32 v44, 16, v46
    v_and_b32 v45, 0xffff0000, v46
    v_mul_f32 v44, 0x3d93cd3a, v44
    v_mul_f32 v45, 0x3d93cd3a, v45
    v_cvt_pk_bf16_f32 v46, v44, v45
    v_lshlrev_b32 v44, 16, v46
    v_and_b32 v45, 0xffff0000, v46
    v_max_f32 v46, v44, v45
    v_cmp_lt_f32 vcc, s71, v46
    s_cbranch_vccnz L_slow2
L_back2:
    v_fma_f32 v44, v44, v9, -s72
    v_fma_f32 v45, v45, v9, -s72
    v_exp_f32 v44, v44
    v_exp_f32 v45, v45
    v_add_f32 v11, v11, v44
    v_cvt_pk_bf16_f32 v44, v44, v44
    v_add_f32 v11, v11, v45
    v_cvt_pk_bf16_f32 v45, v45, v45
    v_and_b32 v36, v4, v44
    v_and_b32 v37, v5, v44
    v_and_b32 v38, v6, v44
    v_and_b32 v39, v7, v44
    v_and_b32 v40, v4, v45
    v_and_b32 v41, v5, v45
    v_and_b32 v42, v6, v45
    v_and_b32 v43, v7, v45
    s_cmp_lg_u32 s5, 1
    s_cbranch_scc1 L_vs2
L_vb2:
    s_waitcnt vmcnt(18)
    v_mfma_f32_16x16x32_bf16 v[24:27], v[36:39], a[48:51], v[24:27]
    v_mfma_f32_16x16x32_bf16 v[28:31], v[36:39], a[52:55], v[28:31]
    v_mfma_f32_16x16x32_bf16 v[32:35], v[36:39], a[56:59], v[32:35]
    v_mfma_f32_16x16x32_bf16 v[24:27], v[40:43], a[60:63], v[24:27]
    v_mfma_f32_16x16x32_bf16 v[28:31], v[40:43], a[64:67], v[28:31]
    v_mfma_f32_16x16x32_bf16 v[32:35], v[40:43], a[68:71], v[32:35]
    buffer_load_dwordx4 a[96:99], v3, s[48:51], s73 offen offset:0 nt
    buffer_load_dwordx4 a[100:103], v3, s[48:51], s73 offen offset:128 nt
    buffer_load_dwordx4 a[104:107], v3, s[48:51], s73 offen offset:256 nt
    buffer_load_dwordx4 a[108:111], v3, s[48:51], s73 offen offset:3072 nt
    buffer_load_dwordx4 a[112:115], v3, s[48:51], s73 offen offset:3200 nt
    buffer_load_dwordx4 a[116:119], v3, s[48:51], s73 offen offset:3328 nt
    s_sub_u32 s10, s10, 1
    s_cbranch_scc1 L_wl2
L_nx2:
    s_sub_u32 s0, s0, 1
    s_cbranch_scc1 L_sw3
L_sb3:
    s_waitcnt vmcnt(18)
    s_cmp_eq_u32 s4, 0
    s_cbranch_scc0 L_nd3
    s_mov_b64 exec, 1
    ds_add_rtn_u32 v92, v94, v93
    s_mov_b64 exec, -1
L_nd3:
    v_dot2_f32_bf16 v44, v168, v12, 0
    v_dot2_f32_bf16 v45, v180, v12, 0
    v_dot2_f32_bf16 v46, v169, v13, 0
    v_dot2_f32_bf16 v47, v181, v13, 0
    v_dot2_f32_bf16 v44, v170, v14, v44
    v_dot2_f32_bf16 v45, v182, v14, v45
    v_dot2_f32_bf16 v46, v171, v15, v46
    v_dot2_f32_bf16 v47, v183, v15, v47
    v_dot2_f32_bf16 v44, v172, v16, v44
    v_dot2_f32_bf16 v45, v184, v16, v45
    v_dot2_f32_bf16 v46, v173, v17, v46
    v_dot2_f32_bf16 v47, v185, v17, v47
    v_dot2_f32_bf16 v44, v174, v18, v44
    v_dot2_f32_bf16 v45, v186, v18, v45
    v_dot2_f32_bf16 v46, v175, v19, v46
    v_dot2_f32_bf16 v47, v187, v19, v47
    v_dot2_f32_bf16 v44, v176, v20, v44
    v_dot2_f32_bf16 v45, v188, v20, v45
    v_dot2_f32_bf16 v46, v177, v21, v46
    v_dot2_f32_bf16 v47, v189, v21, v47
    v_dot2_f32_bf16 v44, v178, v22, v44
    v_dot2_f32_bf16 v45, v190, v22, v45
    v_dot2_f32_bf16 v46, v179, v23, v46
    v_dot2_f32_bf16 v47, v191, v23, v47
    s_cmp_lg_u32 s4, 0
    s_cbranch_scc1 L_sp3
    s_waitcnt lgkmcnt(0)
    v_readfirstlane_b32 s8, v92
    s_mov_b32 s5, 1
    s_cmp_ge_u32 s8, s83
    s_cbranch_scc1 L_ck3
L_cb3:
    s_mul_i32 s73, s8, s41
    s_add_u32 s73, s73, s11
    s_mul_i32 s73, s73, 6144
    buffer_load_dwordx4 v[216:219], v3, s[44:47], s73 offen offset:0 nt
    buffer_load_dwordx4 v[220:223], v3, s[44:47], s73 offen offset:128 nt
    buffer_load_dwordx4 v[224:227], v3, s[44:47], s73 offen offset:256 nt
    buffer_load_dwordx4 v[228:231], v3, s[44:47], s73 offen offset:3072 nt
    buffer_load_dwordx4 v[232:235], v3, s[44:47], s73 offen offset:3200 nt
    buffer_load_dwordx4 v[236:239], v3, s[44:47], s73 offen offset:3328 nt
L_nk3:
    v_add_f32 v44, v44, v46
    v_add_f32 v45, v45, v47
    s_nop 0
    v_add_f32_dpp v44, v44, v44 quad_perm:[1,0,3,2] row_mask:0xf bank_mask:0xf
    v_add_f32_dpp v45, v45, v45 quad_perm:[1,0,3,2] row_mask:0xf bank_mask:0xf
    s_nop 0
    v_add_f32_dpp v44, v44, v44 quad_perm:[2,3,0,1] row_mask:0xf bank_mask:0xf
    v_add_f32_dpp v45, v45, v45 quad_perm:[2,3,0,1] row_mask:0xf bank_mask:0xf
    s_nop 0
    v_add_f32_dpp v44, v44, v44 row_half_mirror row_mask:0xf bank_mask:0xf
    v_add_f32_dpp v45, v45, v45 row_half_mirror row_mask:0xf bank_mask:0xf
    v_cvt_pk_bf16_f32 v46, v44, v45
    v_lshlrev_b32 v44, 16, v46
    v_and_b32 v45, 0xffff0000, v46
    v_mul_f32 v44, 0x3d93cd3a, v44
    v_mul_f32 v45, 0x3d93cd3a, v45
    v_cvt_pk_bf16_f32 v46, v44, v45
    v_lshlrev_b32 v44, 16, v46
    v_and_b32 v45, 0xffff0000, v46
    v_max_f32 v46, v44, v45
    v_cmp_lt_f32 vcc, s71, v46
    s_cbranch_vccnz L_slow3
L_back3:
    v_fma_f32 v44, v44, v9, -s72
    v_fma_f32 v45, v45, v9, -s72
    v_exp_f32 v44, v44
    v_exp_f32 v45, v45
    v_add_f32 v11, v11, v44
    v_cvt_pk_bf16_f32 v44, v44, v44
    v_add_f32 v11, v11, v45
    v_cvt_pk_bf16_f32 v45, v45, v45
    v_and_b32 v36, v4, v44
    v_and_b32 v37, v5, v44
    v_and_b32 v38, v6, v44
    v_and_b32 v39, v7, v44
    v_and_b32 v40, v4, v45
    v_and_b32 v41, v5, v45
    v_and_b32 v42, v6, v45
    v_and_b32 v43, v7, v45
    s_cmp_lg_u32 s5, 1
    s_cbranch_scc1 L_vs3
L_vb3:
    s_waitcnt vmcnt(18)
    v_mfma_f32_16x16x32_bf16 v[24:27], v[36:39], a[72:75], v[24:27]
    v_mfma_f32_16x16x32_bf16 v[28:31], v[36:39], a[76:79], v[28:31]
    v_mfma_f32_16x16x32_bf16 v[32:35], v[36:39], a[80:83], v[32:35]
    v_mfma_f32_16x16x32_bf16 v[24:27], v[40:43], a[84:87], v[24:27]
    v_mfma_f32_16x16x32_bf16 v[28:31], v[40:43], a[88:91], v[28:31]
    v_mfma_f32_16x16x32_bf16 v[32:35], v[40:43], a[92:95], v[32:35]
    buffer_load_dwordx4 a[120:123], v3, s[48:51], s73 offen offset:0 nt
    buffer_load_dwordx4 a[124:127], v3, s[48:51], s73 offen offset:128 nt
    buffer_load_dwordx4 a[128:131], v3, s[48:51], s73 offen offset:256 nt
    buffer_load_dwordx4 a[132:135], v3, s[48:51], s73 offen offset:3072 nt
    buffer_load_dwordx4 a[136:139], v3, s[48:51], s73 offen offset:3200 nt
    buffer_load_dwordx4 a[140:143], v3, s[48:51], s73 offen offset:3328 nt
    s_sub_u32 s10, s10, 1
    s_cbranch_scc1 L_wl3
L_nx3:
    s_sub_u32 s0, s0, 1
    s_cbranch_scc1 L_sw4
L_sb4:
    s_waitcnt vmcnt(18)
    s_cmp_eq_u32 s4, 0
    s_cbranch_scc0 L_nd4
    s_mov_b64 exec, 1
    ds_add_rtn_u32 v92, v94, v93
    s_mov_b64 exec, -1
L_nd4:
    v_dot2_f32_bf16 v44, v192, v12, 0
    v_dot2_f32_bf16 v45, v204, v12, 0
    v_dot2_f32_bf16 v46, v193, v13, 0
    v_dot2_f32_bf16 v47, v205, v13, 0
    v_dot2_f32_bf16 v44, v194, v14, v44
    v_dot2_f32_bf16 v45, v206, v14, v45
    v_dot2_f32_bf16 v46, v195, v15, v46
    v_dot2_f32_bf16 v47, v207, v15, v47
    v_dot2_f32_bf16 v44, v196, v16, v44
    v_dot2_f32_bf16 v45, v208, v16, v45
    v_dot2_f32_bf16 v46, v197, v17, v46
    v_dot2_f32_bf16 v47, v209, v17, v47
    v_dot2_f32_bf16 v44, v198, v18, v44
    v_dot2_f32_bf16 v45, v210, v18, v45
    v_dot2_f32_bf16 v46, v199, v19, v46
    v_dot2_f32_bf16 v47, v211, v19, v47
    v_dot2_f32_bf16 v44, v200, v20, v44
    v_dot2_f32_bf16 v45, v212, v20, v45
    v_dot2_f32_bf16 v46, v201, v21, v46
    v_dot2_f32_bf16 v47, v213, v21, v47
    v_dot2_f32_bf16 v44, v202, v22, v44
    v_dot2_f32_bf16 v45, v214, v22, v45
    v_dot2_f32_bf16 v46, v203, v23, v46
    v_dot2_f32_bf16 v47, v215, v23, v47
    s_cmp_lg_u32 s4, 0
    s_cbranch_scc1 L_sp4
    s_waitcnt lgkmcnt(0)
    v_readfirstlane_b32 s8, v92
    s_mov_b32 s5, 1
    s_cmp_ge_u32 s8, s83
    s_cbranch_scc1 L_ck4
L_cb4:
    s_mul_i32 s73, s8, s41
    s_add_u32 s73, s73, s11
    s_mul_i32 s73, s73, 6144
    buffer_load_dwordx4 v[96:99], v3, s[44:47], s73 offen offset:0 nt
    buffer_load_dwordx4 v[100:103], v3, s[44:47], s73 offen offset:128 nt
    buffer_load_dwordx4 v[104:107], v3, s[44:47], s73 offen offset:256 nt
    buffer_load_dwordx4 v[108:111], v3, s[44:47], s73 offen offset:3072 nt
    buffer_load_dwordx4 v[112:115], v3, s[44:47], s73 offen offset:3200 nt
    buffer_load_dwordx4 v[116:119], v3, s[44:47], s73 offen offset:3328 nt
L_nk4:
    v_add_f32 v44, v44, v46
    v_add_f32 v45, v45, v47
    s_nop 0
    v_add_f32_dpp v44, v44, v44 quad_perm:[1,0,3,2] row_mask:0xf bank_mask:0xf
    v_add_f32_dpp v45, v45, v45 quad_perm:[1,0,3,2] row_mask:0xf bank_mask:0xf
    s_nop 0
    v_add_f32_dpp v44, v44, v44 quad_perm:[2,3,0,1] row_mask:0xf bank_mask:0xf
    v_add_f32_dpp v45, v45, v45 quad_perm:[2,3,0,1] row_mask:0xf bank_mask:0xf
    s_nop 0
    v_add_f32_dpp v44, v44, v44 row_half_mirror row_mask:0xf bank_mask:0xf
    v_add_f32_dpp v45, v45, v45 row_half_mirror row_mask:0xf bank_mask:0xf
    v_cvt_pk_bf16_f32 v46, v44, v45
    v_lshlrev_b32 v44, 16, v46
    v_and_b32 v45, 0xffff0000, v46
    v_mul_f32 v44, 0x3d93cd3a, v44
    v_mul_f32 v45, 0x3d93cd3a, v45
    v_cvt_pk_bf16_f32 v46, v44, v45
    v_lshlrev_b32 v44, 16, v46
    v_and_b32 v45, 0xffff0000, v46
    v_max_f32 v46, v44, v45
    v_cmp_lt_f32 vcc, s71, v46
    s_cbranch_vccnz L_slow4
L_back4:
    v_fma_f32 v44, v44, v9, -s72
    v_fma_f32 v45, v45, v9, -s72
    v_exp_f32 v44, v44
    v_exp_f32 v45, v45
    v_add_f32 v11, v11, v44
    v_cvt_pk_bf16_f32 v44, v44, v44
    v_add_f32 v11, v11, v45
    v_cvt_pk_bf16_f32 v45, v45, v45
    v_and_b32 v36, v4, v44
    v_and_b32 v37, v5, v44
    v_and_b32 v38, v6, v44
    v_and_b32 v39, v7, v44
    v_and_b32 v40, v4, v45
    v_and_b32 v41, v5, v45
    v_and_b32 v42, v6, v45
    v_and_b32 v43, v7, v45
    s_cmp_lg_u32 s5, 1
    s_cbranch_scc1 L_vs4
L_vb4:
    s_waitcnt vmcnt(18)
    v_mfma_f32_16x16x32_bf16 v[24:27], v[36:39], a[96:99], v[24:27]
    v_mfma_f32_16x16x32_bf16 v[28:31], v[36:39], a[100:103], v[28:31]
    v_mfma_f32_16x16x32_bf16 v[32:35], v[36:39], a[104:107], v[32:35]
    v_mfma_f32_16x16x32_bf16 v[24:27], v[40:43], a[108:111], v[24:27]
    v_mfma_f32_16x16x32_bf16 v[28:31], v[40:43], a[112:115], v[28:31]
    v_mfma_f32_16x16x32_bf16 v[32:35], v[40:43], a[116:119], v[32:35]
    buffer_load_dwordx4 a[0:3], v3, s[48:51], s73 offen offset:0 nt
    buffer_load_dwordx4 a[4:7], v3, s[48:51], s73 offen offset:128 nt
    buffer_load_dwordx4 a[8:11], v3, s[48:51], s73 offen offset:256 nt
    buffer_load_dwordx4 a[12:15], v3, s[48:51], s73 offen offset:3072 nt
    buffer_load_dwordx4 a[16:19], v3, s[48:51], s73 offen offset:3200 nt
    buffer_load_dwordx4 a[20:23], v3, s[48:51], s73 offen offset:3328 nt
    s_sub_u32 s10, s10, 1
    s_cbranch_scc1 L_wl4
L_nx4:
    s_sub_u32 s0, s0, 1
    s_cbranch_scc1 L_sw5
L_sb5:
    s_waitcnt vmcnt(18)
    s_cmp_eq_u32 s4, 0
    s_cbranch_scc0 L_nd5
    s_mov_b64 exec, 1
    ds_add_rtn_u32 v92, v94, v93
    s_mov_b64 exec, -1
L_nd5:
    v_dot2_f32_bf16 v44, v216, v12, 0
    v_dot2_f32_bf16 v45, v228, v12, 0
    v_dot2_f32_bf16 v46, v217, v13, 0
    v_dot2_f32_bf16 v47, v229, v13, 0
    v_dot2_f32_bf16 v44, v218, v14, v44
    v_dot2_f32_bf16 v45, v230, v14, v45
    v_dot2_f32_bf16 v46, v219, v15, v46
    v_dot2_f32_bf16 v47, v231, v15, v47
    v_dot2_f32_bf16 v44, v220, v16, v44
    v_dot2_f32_bf16 v45, v232, v16, v45
    v_dot2_f32_bf16 v46, v221, v17, v46
    v_dot2_f32_bf16 v47, v233, v17, v47
    v_dot2_f32_bf16 v44, v222, v18, v44
    v_dot2_f32_bf16 v45, v234, v18, v45
    v_dot2_f32_bf16 v46, v223, v19, v46
    v_dot2_f32_bf16 v47, v235, v19, v47
    v_dot2_f32_bf16 v44, v224, v20, v44
    v_dot2_f32_bf16 v45, v236, v20, v45
    v_dot2_f32_bf16 v46, v225, v21, v46
    v_dot2_f32_bf16 v47, v237, v21, v47
    v_dot2_f32_bf16 v44, v226, v22, v44
    v_dot2_f32_bf16 v45, v238, v22, v45
    v_dot2_f32_bf16 v46, v227, v23, v46
    v_dot2_f32_bf16 v47, v239, v23, v47
    s_cmp_lg_u32 s4, 0
    s_cbranch_scc1 L_sp5
    s_waitcnt lgkmcnt(0)
    v_readfirstlane_b32 s8, v92
    s_mov_b32 s5, 1
    s_cmp_ge_u32 s8, s83
    s_cbranch_scc1 L_ck5
L_cb5:
    s_mul_i32 s73, s8, s41
    s_add_u32 s73, s73, s11
    s_mul_i32 s73, s73, 6144
    buffer_load_dwordx4 v[120:123], v3, s[44:47], s73 offen offset:0 nt
    buffer_load_dwordx4 v[124:127], v3, s[44:47], s73 offen offset:128 nt
    buffer_load_dwordx4 v[128:131], v3, s[44:47], s73 offen offset:256 nt
    buffer_load_dwordx4 v[132:135], v3, s[44:47], s73 offen offset:3072 nt
    buffer_load_dwordx4 v[136:139], v3, s[44:47], s73 offen offset:3200 nt
    buffer_load_dwordx4 v[140:143], v3, s[44:47], s73 offen offset:3328 nt
L_nk5:
    v_add_f32 v44, v44, v46
    v_add_f32 v45, v45, v47
    s_nop 0
    v_add_f32_dpp v44, v44, v44 quad_perm:[1,0,3,2] row_mask:0xf bank_mask:0xf
    v_add_f32_dpp v45, v45, v45 quad_perm:[1,0,3,2] row_mask:0xf bank_mask:0xf
    s_nop 0
    v_add_f32_dpp v44, v44, v44 quad_perm:[2,3,0,1] row_mask:0xf bank_mask:0xf
    v_add_f32_dpp v45, v45, v45 quad_perm:[2,3,0,1] row_mask:0xf bank_mask:0xf
    s_nop 0
    v_add_f32_dpp v44, v44, v44 row_half_mirror row_mask:0xf bank_mask:0xf
    v_add_f32_dpp v45, v45, v45 row_half_mirror row_mask:0xf bank_mask:0xf
    v_cvt_pk_bf16_f32 v46, v44, v45
    v_lshlrev_b32 v44, 16, v46
    v_and_b32 v45, 0xffff0000, v46
    v_mul_f32 v44, 0x3d93cd3a, v44
    v_mul_f32 v45, 0x3d93cd3a, v45
    v_cvt_pk_bf16_f32 v46, v44, v45
    v_lshlrev_b32 v44, 16, v46
    v_and_b32 v45, 0xffff0000, v46
    v_max_f32 v46, v44, v45
    v_cmp_lt_f32 vcc, s71, v46
    s_cbranch_vccnz L_slow5
L_back5:
    v_fma_f32 v44, v44, v9, -s72
    v_fma_f32 v45, v45, v9, -s72
    v_exp_f32 v44, v44
    v_exp_f32 v45, v45
    v_add_f32 v11, v11, v44
    v_cvt_pk_bf16_f32 v44, v44, v44
    v_add_f32 v11, v11, v45
    v_cvt_pk_bf16_f32 v45, v45, v45
    v_and_b32 v36, v4, v44
    v_and_b32 v37, v5, v44
    v_and_b32 v38, v6, v44
    v_and_b32 v39, v7, v44
    v_and_b32 v40, v4, v45
    v_and_b32 v41, v5, v45
    v_and_b32 v42, v6, v45
    v_and_b32 v43, v7, v45
    s_cmp_lg_u32 s5, 1
    s_cbranch_scc1 L_vs5
L_vb5:
    s_waitcnt vmcnt(18)
    v_mfma_f32_16x16x32_bf16 v[24:27], v[36:39], a[120:123], v[24:27]
    v_mfma_f32_16x16x32_bf16 v[28:31], v[36:39], a[124:127], v[28:31]
    v_mfma_f32_16x16x32_bf16 v[32:35], v[36:39], a[128:131], v[32:35]
    v_mfma_f32_16x16x32_bf16 v[24:27], v[40:43], a[132:135], v[24:27]
    v_mfma_f32_16x16x32_bf16 v[28:31], v[40:43], a[136:139], v[28:31]
    v_mfma_f32_16x16x32_bf16 v[32:35], v[40:43], a[140:143], v[32:35]
    buffer_load_dwordx4 a[24:27], v3, s[48:51], s73 offen offset:0 nt
    buffer_load_dwordx4 a[28:31], v3, s[48:51], s73 offen offset:128 nt
    buffer_load_dwordx4 a[32:35], v3, s[48:51], s73 offen offset:256 nt
    buffer_load_dwordx4 a[36:39], v3, s[48:51], s73 offen offset:3072 nt
    buffer_load_dwordx4 a[40:43], v3, s[48:51], s73 offen offset:3200 nt
    buffer_load_dwordx4 a[44:47], v3, s[48:51], s73 offen offset:3328 nt
    s_sub_u32 s10, s10, 1
    s_cbranch_scc1 L_wl5
L_nx5:
    s_branch L_loop
L_sp0:
    s_mov_b32 s5, 0
    s_cmp_eq_u32 s4, 3
    s_cbranch_scc1 L_nk0
    s_sub_u32 s6, s6, 1
    s_cmp_eq_u32 s6, 0
    s_cselect_b32 s4, 0, 2
    s_branch L_nk0
L_ck0:
    s_call_b64 s[14:15], L_chunk
    s_cmp_eq_u32 s4, 3
    s_cbranch_scc0 L_cb0
    s_branch L_nk0
L_vs0:
    s_cmp_eq_u32 s5, 0
    s_cbranch_scc1 L_v00
    s_call_b64 s[14:15], L_grant
    s_branch L_vb0
L_v00:
    s_cmp_eq_u32 s4, 3
    s_cbranch_scc1 L_dr0
    v_mfma_f32_16x16x32_bf16 v[24:27], v[36:39], a[0:3], v[24:27]
    v_mfma_f32_16x16x32_bf16 v[28:31], v[36:39], a[4:7], v[28:31]
    v_mfma_f32_16x16x32_bf16 v[32:35], v[36:39], a[8:11], v[32:35]
    v_mfma_f32_16x16x32_bf16 v[24:27], v[40:43], a[12:15], v[24:27]
    v_mfma_f32_16x16x32_bf16 v[28:31], v[40:43], a[16:19], v[28:31]
    v_mfma_f32_16x16x32_bf16 v[32:35], v[40:43], a[20:23], v[32:35]
    s_branch L_nx0
L_dr0:
    s_cmp_eq_u32 s7, 0
    s_cbranch_scc1 L_dz0
    s_waitcnt vmcnt(12)
    v_mfma_f32_16x16x32_bf16 v[24:27], v[36:39], a[0:3], v[24:27]
    v_mfma_f32_16x16x32_bf16 v[28:31], v[36:39], a[4:7], v[28:31]
    v_mfma_f32_16x16x32_bf16 v[32:35], v[36:39], a[8:11], v[32:35]
    v_mfma_f32_16x16x32_bf16 v[24:27], v[40:43], a[12:15], v[24:27]
    v_mfma_f32_16x16x32_bf16 v[28:31], v[40:43], a[16:19], v[28:31]
    v_mfma_f32_16x16x32_bf16 v[32:35], v[40:43], a[20:23], v[32:35]
    s_mov_b32 s7, 0
    s_waitcnt vmcnt(6)
    s_branch L_nx0
L_dz0:
    s_waitcnt vmcnt(0)
    v_mfma_f32_16x16x32_bf16 v[24:27], v[36:39], a[0:3], v[24:27]
    v_mfma_f32_16x16x32_bf16 v[28:31], v[36:39], a[4:7], v[28:31]
    v_mfma_f32_16x16x32_bf16 v[32:35], v[36:39], a[8:11], v[32:35]
    v_mfma_f32_16x16x32_bf16 v[24:27], v[40:43], a[12:15], v[24:27]
    v_mfma_f32_16x16x32_bf16 v[28:31], v[40:43], a[16:19], v[28:31]
    v_mfma_f32_16x16x32_bf16 v[32:35], v[40:43], a[20:23], v[32:35]
    s_branch L_end
L_wl0:
    s_call_b64 s[14:15], L_event
    s_branch L_nx0
L_sw0:
    s_call_b64 s[14:15], L_switch
    s_branch L_sb0
L_slow0:
    v_max_f32_dpp v46, v46, v46 row_ror:8 row_mask:0xf bank_mask:0xf
    v_mov_b32 v47, v46
    s_nop 1
    v_permlane16_swap_b32 v46, v47
    v_max_f32 v46, v46, v47
    v_mov_b32 v47, v46
    s_nop 1
    v_permlane32_swap_b32 v46, v47
    v_max_f32 v46, v46, v47
    v_mul_f32 v47, v9, v46
    v_sub_f32 v48, s72, v47
    v_exp_f32 v48, v48
    v_readfirstlane_b32 s71, v46
    v_readfirstlane_b32 s72, v47
    v_mul_f32 v11, v11, v48
    v_pk_mul_f32 v[24:25], v[24:25], v[48:49] op_sel:[0,0] op_sel_hi:[1,0]
    v_pk_mul_f32 v[26:27], v[26:27], v[48:49] op_sel:[0,0] op_sel_hi:[1,0]
    v_pk_mul_f32 v[28:29], v[28:29], v[48:49] op_sel:[0,0] op_sel_hi:[1,0]
    v_pk_mul_f32 v[30:31], v[30:31], v[48:49] op_sel:[0,0] op_sel_hi:[1,0]
    v_pk_mul_f32 v[32:33], v[32:33], v[48:49] op_sel:[0,0] op_sel_hi:[1,0]
    v_pk_mul_f32 v[34:35], v[34:35], v[48:49] op_sel:[0,0] op_sel_hi:[1,0]
    s_branch L_back0
L_sp1:
    s_mov_b32 s5, 0
    s_cmp_eq_u32 s4, 3
    s_cbranch_scc1 L_nk1
    s_sub_u32 s6, s6, 1
    s_cmp_eq_u32 s6, 0
    s_cselect_b32 s4, 0, 2
    s_branch L_nk1
L_ck1:
    s_call_b64 s[14:15], L_chunk
    s_cmp_eq_u32 s4, 3
    s_cbranch_scc0 L_cb1
    s_branch L_nk1
L_vs1:
    s_cmp_eq_u32 s5, 0
    s_cbranch_scc1 L_v01
    s_call_b64 s[14:15], L_grant
    s_branch L_vb1
L_v01:
    s_cmp_eq_u32 s4, 3
    s_cbranch_scc1 L_dr1
    v_mfma_f32_16x16x32_bf16 v[24:27], v[36:39], a[24:27], v[24:27]
    v_mfma_f32_16x16x32_bf16 v[28:31], v[36:39], a[28:31], v[28:31]
    v_mfma_f32_16x16x32_bf16 v[32:35], v[36:39], a[32:35], v[32:35]
    v_mfma_f32_16x16x32_bf16 v[24:27], v[40:43], a[36:39], v[24:27]
    v_mfma_f32_16x16x32_bf16 v[28:31], v[40:43], a[40:43], v[28:31]
    v_mfma_f32_16x16x32_bf16 v[32:35], v[40:43], a[44:47], v[32:35]
    s_branch L_nx1
L_dr1:
    s_cmp_eq_u32 s7, 0
    s_cbranch_scc1 L_dz1
    s_waitcnt vmcnt(12)
    v_mfma_f32_16x16x32_bf16 v[24:27], v[36:39], a[24:27], v[24:27]
    v_mfma_f32_16x16x32_bf16 v[28:31], v[36:39], a[28:31], v[28:31]
    v_mfma_f32_16x16x32_bf16 v[32:35], v[36:39], a[32:35], v[32:35]
    v_mfma_f32_16x16x32_bf16 v[24:27], v[40:43], a[36:39], v[24:27]
    v_mfma_f32_16x16x32_bf16 v[28:31], v[40:43], a[40:43], v[28:31]
    v_mfma_f32_16x16x32_bf16 v[32:35], v[40:43], a[44:47], v[32:35]
    s_mov_b32 s7, 0
    s_waitcnt vmcnt(6)
    s_branch L_nx1
L_dz1:
    s_waitcnt vmcnt(0)
    v_mfma_f32_16x16x32_bf16 v[24:27], v[36:39], a[24:27], v[24:27]
    v_mfma_f32_16x16x32_bf16 v[28:31], v[36:39], a[28:31], v[28:31]
    v_mfma_f32_16x16x32_bf16 v[32:35], v[36:39], a[32:35], v[32:35]
    v_mfma_f32_16x16x32_bf16 v[24:27], v[40:43], a[36:39], v[24:27]
    v_mfma_f32_16x16x32_bf16 v[28:31], v[40:43], a[40:43], v[28:31]
    v_mfma_f32_16x16x32_bf16 v[32:35], v[40:43], a[44:47], v[32:35]
    s_branch L_end
L_wl1:
    s_call_b64 s[14:15], L_event
    s_branch L_nx1
L_sw1:
    s_call_b64 s[14:15], L_switch
    s_branch L_sb1
L_slow1:
    v_max_f32_dpp v46, v46, v46 row_ror:8 row_mask:0xf bank_mask:0xf
    v_mov_b32 v47, v46
    s_nop 1
    v_permlane16_swap_b32 v46, v47
    v_max_f32 v46, v46, v47
    v_mov_b32 v47, v46
    s_nop 1
    v_permlane32_swap_b32 v46, v47
    v_max_f32 v46, v46, v47
    v_mul_f32 v47, v9, v46
    v_sub_f32 v48, s72, v47
    v_exp_f32 v48, v48
    v_readfirstlane_b32 s71, v46
    v_readfirstlane_b32 s72, v47
    v_mul_f32 v11, v11, v48
    v_pk_mul_f32 v[24:25], v[24:25], v[48:49] op_sel:[0,0] op_sel_hi:[1,0]
    v_pk_mul_f32 v[26:27], v[26:27], v[48:49] op_sel:[0,0] op_sel_hi:[1,0]
    v_pk_mul_f32 v[28:29], v[28:29], v[48:49] op_sel:[0,0] op_sel_hi:[1,0]
    v_pk_mul_f32 v[30:31], v[30:31], v[48:49] op_sel:[0,0] op_sel_hi:[1,0]
    v_pk_mul_f32 v[32:33], v[32:33], v[48:49] op_sel:[0,0] op_sel_hi:[1,0]
    v_pk_mul_f32 v[34:35], v[34:35], v[48:49] op_sel:[0,0] op_sel_hi:[1,0]
    s_branch L_back1
L_sp2:
    s_mov_b32 s5, 0
    s_cmp_eq_u32 s4, 3
    s_cbranch_scc1 L_nk2
    s_sub_u32 s6, s6, 1
    s_cmp_eq_u32 s6, 0
    s_cselect_b32 s4, 0, 2
    s_branch L_nk2
L_ck2:
    s_call_b64 s[14:15], L_chunk
    s_cmp_eq_u32 s4, 3
    s_cbranch_scc0 L_cb2
    s_branch L_nk2
L_vs2:
    s_cmp_eq_u32 s5, 0
    s_cbranch_scc1 L_v02
    s_call_b64 s[14:15], L_grant
    s_branch L_vb2
L_v02:
    s_cmp_eq_u32 s4, 3
    s_cbranch_scc1 L_dr2
    v_mfma_f32_16x16x32_bf16 v[24:27], v[36:39], a[48:51], v[24:27]
    v_mfma_f32_16x16x32_bf16 v[28:31], v[36:39], a[52:55], v[28:31]
    v_mfma_f32_16x16x32_bf16 v[32:35], v[36:39], a[56:59], v[32:35]
    v_mfma_f32_16x16x32_bf16 v[24:27], v[40:43], a[60:63], v[24:27]
    v_mfma_f32_16x16x32_bf16 v[28:31], v[40:43], a[64:67], v[28:31]
    v_mfma_f32_16x16x32_bf16 v[32:35], v[40:43], a[68:71], v[32:35]
    s_branch L_nx2
L_dr2:
    s_cmp_eq_u32 s7, 0
    s_cbranch_scc1 L_dz2
    s_waitcnt vmcnt(12)
    v_mfma_f32_16x16x32_bf16 v[24:27], v[36:39], a[48:51], v[24:27]
    v_mfma_f32_16x16x32_bf16 v[28:31], v[36:39], a[52:55], v[28:31]
    v_mfma_f32_16x16x32_bf16 v[32:35], v[36:39], a[56:59], v[32:35]
    v_mfma_f32_16x16x32_bf16 v[24:27], v[40:43], a[60:63], v[24:27]
    v_mfma_f32_16x16x32_bf16 v[28:31], v[40:43], a[64:67], v[28:31]
    v_mfma_f32_16x16x32_bf16 v[32:35], v[40:43], a[68:71], v[32:35]
    s_mov_b32 s7, 0
    s_waitcnt vmcnt(6)
    s_branch L_nx2
L_dz2:
    s_waitcnt vmcnt(0)
    v_mfma_f32_16x16x32_bf16 v[24:27], v[36:39], a[48:51], v[24:27]
    v_mfma_f32_16x16x32_bf16 v[28:31], v[36:39], a[52:55], v[28:31]
    v_mfma_f32_16x16x32_bf16 v[32:35], v[36:39], a[56:59], v[32:35]
    v_mfma_f32_16x16x32_bf16 v[24:27], v[40:43], a[60:63], v[24:27]
    v_mfma_f32_16x16x32_bf16 v[28:31], v[40:43], a[64:67], v[28:31]
    v_mfma_f32_16x16x32_bf16 v[32:35], v[40:43], a[68:71], v[32:35]
    s_branch L_end
L_wl2:
    s_call_b64 s[14:15], L_event
    s_branch L_nx2
L_sw2:
    s_call_b64 s[14:15], L_switch
    s_branch L_sb2
L_slow2:
    v_max_f32_dpp v46, v46, v46 row_ror:8 row_mask:0xf bank_mask:0xf
    v_mov_b32 v47, v46
    s_nop 1
    v_permlane16_swap_b32 v46, v47
    v_max_f32 v46, v46, v47
    v_mov_b32 v47, v46
    s_nop 1
    v_permlane32_swap_b32 v46, v47
    v_max_f32 v46, v46, v47
    v_mul_f32 v47, v9, v46
    v_sub_f32 v48, s72, v47
    v_exp_f32 v48, v48
    v_readfirstlane_b32 s71, v46
    v_readfirstlane_b32 s72, v47
    v_mul_f32 v11, v11, v48
    v_pk_mul_f32 v[24:25], v[24:25], v[48:49] op_sel:[0,0] op_sel_hi:[1,0]
    v_pk_mul_f32 v[26:27], v[26:27], v[48:49] op_sel:[0,0] op_sel_hi:[1,0]
    v_pk_mul_f32 v[28:29], v[28:29], v[48:49] op_sel:[0,0] op_sel_hi:[1,0]
    v_pk_mul_f32 v[30:31], v[30:31], v[48:49] op_sel:[0,0] op_sel_hi:[1,0]
    v_pk_mul_f32 v[32:33], v[32:33], v[48:49] op_sel:[0,0] op_sel_hi:[1,0]
    v_pk_mul_f32 v[34:35], v[34:35], v[48:49] op_sel:[0,0] op_sel_hi:[1,0]
    s_branch L_back2
L_sp3:
    s_mov_b32 s5, 0
    s_cmp_eq_u32 s4, 3
    s_cbranch_scc1 L_nk3
    s_sub_u32 s6, s6, 1
    s_cmp_eq_u32 s6, 0
    s_cselect_b32 s4, 0, 2
    s_branch L_nk3
L_ck3:
    s_call_b64 s[14:15], L_chunk
    s_cmp_eq_u32 s4, 3
    s_cbranch_scc0 L_cb3
    s_branch L_nk3
L_vs3:
    s_cmp_eq_u32 s5, 0
    s_cbranch_scc1 L_v03
    s_call_b64 s[14:15], L_grant
    s_branch L_vb3
L_v03:
    s_cmp_eq_u32 s4, 3
    s_cbranch_scc1 L_dr3
    v_mfma_f32_16x16x32_bf16 v[24:27], v[36:39], a[72:75], v[24:27]
    v_mfma_f32_16x16x32_bf16 v[28:31], v[36:39], a[76:79], v[28:31]
    v_mfma_f32_16x16x32_bf16 v[32:35], v[36:39], a[80:83], v[32:35]
    v_mfma_f32_16x16x32_bf16 v[24:27], v[40:43], a[84:87], v[24:27]
    v_mfma_f32_16x16x32_bf16 v[28:31], v[40:43], a[88:91], v[28:31]
    v_mfma_f32_16x16x32_bf16 v[32:35], v[40:43], a[92:95], v[32:35]
    s_branch L_nx3
L_dr3:
    s_cmp_eq_u32 s7, 0
    s_cbranch_scc1 L_dz3
    s_waitcnt vmcnt(12)
    v_mfma_f32_16x16x32_bf16 v[24:27], v[36:39], a[72:75], v[24:27]
    v_mfma_f32_16x16x32_bf16 v[28:31], v[36:39], a[76:79], v[28:31]
    v_mfma_f32_16x16x32_bf16 v[32:35], v[36:39], a[80:83], v[32:35]
    v_mfma_f32_16x16x32_bf16 v[24:27], v[40:43], a[84:87], v[24:27]
    v_mfma_f32_16x16x32_bf16 v[28:31], v[40:43], a[88:91], v[28:31]
    v_mfma_f32_16x16x32_bf16 v[32:35], v[40:43], a[92:95], v[32:35]
    s_mov_b32 s7, 0
    s_waitcnt vmcnt(6)
    s_branch L_nx3
L_dz3:
    s_waitcnt vmcnt(0)
    v_mfma_f32_16x16x32_bf16 v[24:27], v[36:39], a[72:75], v[24:27]
    v_mfma_f32_16x16x32_bf16 v[28:31], v[36:39], a[76:79], v[28:31]
    v_mfma_f32_16x16x32_bf16 v[32:35], v[36:39], a[80:83], v[32:35]
    v_mfma_f32_16x16x32_bf16 v[24:27], v[40:43], a[84:87], v[24:27]
    v_mfma_f32_16x16x32_bf16 v[28:31], v[40:43], a[88:91], v[28:31]
    v_mfma_f32_16x16x32_bf16 v[32:35], v[40:43], a[92:95], v[32:35]
    s_branch L_end
L_wl3:
    s_call_b64 s[14:15], L_event
    s_branch L_nx3
L_sw3:
    s_call_b64 s[14:15], L_switch
    s_branch L_sb3
L_slow3:
    v_max_f32_dpp v46, v46, v46 row_ror:8 row_mask:0xf bank_mask:0xf
    v_mov_b32 v47, v46
    s_nop 1
    v_permlane16_swap_b32 v46, v47
    v_max_f32 v46, v46, v47
    v_mov_b32 v47, v46
    s_nop 1
    v_permlane32_swap_b32 v46, v47
    v_max_f32 v46, v46, v47
    v_mul_f32 v47, v9, v46
    v_sub_f32 v48, s72, v47
    v_exp_f32 v48, v48
    v_readfirstlane_b32 s71, v46
    v_readfirstlane_b32 s72, v47
    v_mul_f32 v11, v11, v48
    v_pk_mul_f32 v[24:25], v[24:25], v[48:49] op_sel:[0,0] op_sel_hi:[1,0]
    v_pk_mul_f32 v[26:27], v[26:27], v[48:49] op_sel:[0,0] op_sel_hi:[1,0]
    v_pk_mul_f32 v[28:29], v[28:29], v[48:49] op_sel:[0,0] op_sel_hi:[1,0]
    v_pk_mul_f32 v[30:31], v[30:31], v[48:49] op_sel:[0,0] op_sel_hi:[1,0]
    v_pk_mul_f32 v[32:33], v[32:33], v[48:49] op_sel:[0,0] op_sel_hi:[1,0]
    v_pk_mul_f32 v[34:35], v[34:35], v[48:49] op_sel:[0,0] op_sel_hi:[1,0]
    s_branch L_back3
L_sp4:
    s_mov_b32 s5, 0
    s_cmp_eq_u32 s4, 3
    s_cbranch_scc1 L_nk4
    s_sub_u32 s6, s6, 1
    s_cmp_eq_u32 s6, 0
    s_cselect_b32 s4, 0, 2
    s_branch L_nk4
L_ck4:
    s_call_b64 s[14:15], L_chunk
    s_cmp_eq_u32 s4, 3
    s_cbranch_scc0 L_cb4
    s_branch L_nk4
L_vs4:
    s_cmp_eq_u32 s5, 0
    s_cbranch_scc1 L_v04
    s_call_b64 s[14:15], L_grant
    s_branch L_vb4
L_v04:
    s_cmp_eq_u32 s4, 3
    s_cbranch_scc1 L_dr4
    v_mfma_f32_16x16x32_bf16 v[24:27], v[36:39], a[96:99], v[24:27]
    v_mfma_f32_16x16x32_bf16 v[28:31], v[36:39], a[100:103], v[28:31]
    v_mfma_f32_16x16x32_bf16 v[32:35], v[36:39], a[104:107], v[32:35]
    v_mfma_f32_16x16x32_bf16 v[24:27], v[40:43], a[108:111], v[24:27]
    v_mfma_f32_16x16x32_bf16 v[28:31], v[40:43], a[112:115], v[28:31]
    v_mfma_f32_16x16x32_bf16 v[32:35], v[40:43], a[116:119], v[32:35]
    s_branch L_nx4
L_dr4:
    s_cmp_eq_u32 s7, 0
    s_cbranch_scc1 L_dz4
    s_waitcnt vmcnt(12)
    v_mfma_f32_16x16x32_bf16 v[24:27], v[36:39], a[96:99], v[24:27]
    v_mfma_f32_16x16x32_bf16 v[28:31], v[36:39], a[100:103], v[28:31]
    v_mfma_f32_16x16x32_bf16 v[32:35], v[36:39], a[104:107], v[32:35]
    v_mfma_f32_16x16x32_bf16 v[24:27], v[40:43], a[108:111], v[24:27]
    v_mfma_f32_16x16x32_bf16 v[28:31], v[40:43], a[112:115], v[28:31]
    v_mfma_f32_16x16x32_bf16 v[32:35], v[40:43], a[116:119], v[32:35]
    s_mov_b32 s7, 0
    s_waitcnt vmcnt(6)
    s_branch L_nx4
L_dz4:
    s_waitcnt vmcnt(0)
    v_mfma_f32_16x16x32_bf16 v[24:27], v[36:39], a[96:99], v[24:27]
    v_mfma_f32_16x16x32_bf16 v[28:31], v[36:39], a[100:103], v[28:31]
    v_mfma_f32_16x16x32_bf16 v[32:35], v[36:39], a[104:107], v[32:35]
    v_mfma_f32_16x16x32_bf16 v[24:27], v[40:43], a[108:111], v[24:27]
    v_mfma_f32_16x16x32_bf16 v[28:31], v[40:43], a[112:115], v[28:31]
    v_mfma_f32_16x16x32_bf16 v[32:35], v[40:43], a[116:119], v[32:35]
    s_branch L_end
L_wl4:
    s_call_b64 s[14:15], L_event
    s_branch L_nx4
L_sw4:
    s_call_b64 s[14:15], L_switch
    s_branch L_sb4
L_slow4:
    v_max_f32_dpp v46, v46, v46 row_ror:8 row_mask:0xf bank_mask:0xf
    v_mov_b32 v47, v46
    s_nop 1
    v_permlane16_swap_b32 v46, v47
    v_max_f32 v46, v46, v47
    v_mov_b32 v47, v46
    s_nop 1
    v_permlane32_swap_b32 v46, v47
    v_max_f32 v46, v46, v47
    v_mul_f32 v47, v9, v46
    v_sub_f32 v48, s72, v47
    v_exp_f32 v48, v48
    v_readfirstlane_b32 s71, v46
    v_readfirstlane_b32 s72, v47
    v_mul_f32 v11, v11, v48
    v_pk_mul_f32 v[24:25], v[24:25], v[48:49] op_sel:[0,0] op_sel_hi:[1,0]
    v_pk_mul_f32 v[26:27], v[26:27], v[48:49] op_sel:[0,0] op_sel_hi:[1,0]
    v_pk_mul_f32 v[28:29], v[28:29], v[48:49] op_sel:[0,0] op_sel_hi:[1,0]
    v_pk_mul_f32 v[30:31], v[30:31], v[48:49] op_sel:[0,0] op_sel_hi:[1,0]
    v_pk_mul_f32 v[32:33], v[32:33], v[48:49] op_sel:[0,0] op_sel_hi:[1,0]
    v_pk_mul_f32 v[34:35], v[34:35], v[48:49] op_sel:[0,0] op_sel_hi:[1,0]
    s_branch L_back4
L_sp5:
    s_mov_b32 s5, 0
    s_cmp_eq_u32 s4, 3
    s_cbranch_scc1 L_nk5
    s_sub_u32 s6, s6, 1
    s_cmp_eq_u32 s6, 0
    s_cselect_b32 s4, 0, 2
    s_branch L_nk5
L_ck5:
    s_call_b64 s[14:15], L_chunk
    s_cmp_eq_u32 s4, 3
    s_cbranch_scc0 L_cb5
    s_branch L_nk5
L_vs5:
    s_cmp_eq_u32 s5, 0
    s_cbranch_scc1 L_v05
    s_call_b64 s[14:15], L_grant
    s_branch L_vb5
L_v05:
    s_cmp_eq_u32 s4, 3
    s_cbranch_scc1 L_dr5
    v_mfma_f32_16x16x32_bf16 v[24:27], v[36:39], a[120:123], v[24:27]
    v_mfma_f32_16x16x32_bf16 v[28:31], v[36:39], a[124:127], v[28:31]
    v_mfma_f32_16x16x32_bf16 v[32:35], v[36:39], a[128:131], v[32:35]
    v_mfma_f32_16x16x32_bf16 v[24:27], v[40:43], a[132:135], v[24:27]
    v_mfma_f32_16x16x32_bf16 v[28:31], v[40:43], a[136:139], v[28:31]
    v_mfma_f32_16x16x32_bf16 v[32:35], v[40:43], a[140:143], v[32:35]
    s_branch L_nx5
L_dr5:
    s_cmp_eq_u32 s7, 0
    s_cbranch_scc1 L_dz5
    s_waitcnt vmcnt(12)
    v_mfma_f32_16x16x32_bf16 v[24:27], v[36:39], a[120:123], v[24:27]
    v_mfma_f32_16x16x32_bf16 v[28:31], v[36:39], a[124:127], v[28:31]
    v_mfma_f32_16x16x32_bf16 v[32:35], v[36:39], a[128:131], v[32:35]
    v_mfma_f32_16x16x32_bf16 v[24:27], v[40:43], a[132:135], v[24:27]
    v_mfma_f32_16x16x32_bf16 v[28:31], v[40:43], a[136:139], v[28:31]
    v_mfma_f32_16x16x32_bf16 v[32:35], v[40:43], a[140:143], v[32:35]
    s_mov_b32 s7, 0
    s_waitcnt vmcnt(6)
    s_branch L_nx5
L_dz5:
    s_waitcnt vmcnt(0)
    v_mfma_f32_16x16x32_bf16 v[24:27], v[36:39], a[120:123], v[24:27]
    v_mfma_f32_16x16x32_bf16 v[28:31], v[36:39], a[124:127], v[28:31]
    v_mfma_f32_16x16x32_bf16 v[32:35], v[36:39], a[128:131], v[32:35]
    v_mfma_f32_16x16x32_bf16 v[24:27], v[40:43], a[132:135], v[24:27]
    v_mfma_f32_16x16x32_bf16 v[28:31], v[40:43], a[136:139], v[28:31]
    v_mfma_f32_16x16x32_bf16 v[32:35], v[40:43], a[140:143], v[32:35]
    s_branch L_end
L_wl5:
    s_call_b64 s[14:15], L_event
    s_branch L_nx5
L_sw5:
    s_call_b64 s[14:15], L_switch
    s_branch L_sb5
L_slow5:
    v_max_f32_dpp v46, v46, v46 row_ror:8 row_mask:0xf bank_mask:0xf
    v_mov_b32 v47, v46
    s_nop 1
    v_permlane16_swap_b32 v46, v47
    v_max_f32 v46, v46, v47
    v_mov_b32 v47, v46
    s_nop 1
    v_permlane32_swap_b32 v46, v47
    v_max_f32 v46, v46, v47
    v_mul_f32 v47, v9, v46
    v_sub_f32 v48, s72, v47
    v_exp_f32 v48, v48
    v_readfirstlane_b32 s71, v46
    v_readfirstlane_b32 s72, v47
    v_mul_f32 v11, v11, v48
    v_pk_mul_f32 v[24:25], v[24:25], v[48:49] op_sel:[0,0] op_sel_hi:[1,0]
    v_pk_mul_f32 v[26:27], v[26:27], v[48:49] op_sel:[0,0] op_sel_hi:[1,0]
    v_pk_mul_f32 v[28:29], v[28:29], v[48:49] op_sel:[0,0] op_sel_hi:[1,0]
    v_pk_mul_f32 v[30:31], v[30:31], v[48:49] op_sel:[0,0] op_sel_hi:[1,0]
    v_pk_mul_f32 v[32:33], v[32:33], v[48:49] op_sel:[0,0] op_sel_hi:[1,0]
    v_pk_mul_f32 v[34:35], v[34:35], v[48:49] op_sel:[0,0] op_sel_hi:[1,0]
    s_branch L_back5
L_chunk:
    s_cmp_lt_u32 s8, s82
    s_cbranch_scc1 L_ch2
    s_add_u32 s74, s74, 8
    v_mov_b32 v52, s74
    s_mov_b32 s75, 0
L_chs:
    ds_read_b64 v[50:51], v52 offset:20480
    s_add_u32 s75, s75, 1
    s_cmp_gt_u32 s75, 16777216
    s_cbranch_scc1 L_done
    s_waitcnt lgkmcnt(0)
    v_readfirstlane_b32 s76, v51
    v_readfirstlane_b32 s11, v50
    s_cmp_eq_u32 s76, 0
    s_cbranch_scc1 L_chs
    s_cmp_eq_u32 s76, -1
    s_cbranch_scc1 L_chout
    s_sub_u32 s83, s76, 6
    s_max_i32 s83, s83, s82
    s_mov_b32 s82, s76
    s_add_u32 s95, s76, s11
    s_lshl_b32 s76, s85, 11
    s_add_u32 s11, s11, s76
    s_cmp_eq_u32 s74, 8
    s_cselect_b32 s0, 1, s0
    s_mov_b32 s41, 1
    s_branch L_chunk
L_ch2:
    s_cmp_lg_u32 s8, s83
    s_cbranch_scc1 L_chret
    s_mov_b32 s75, 0
L_lf9:
    ds_read_b32 v50, v94 offset:8
    s_add_u32 s75, s75, 1
    s_cmp_gt_u32 s75, 16777216
    s_cbranch_scc1 L_done
    s_waitcnt lgkmcnt(0)
    v_cmp_ne_u32 vcc, 0, v50
    s_cbranch_vccz L_lf9
    s_sub_u32 s40, 2048, s95
    s_lshr_b32 s40, s40, 6
    s_max_u32 s40, s40, 4
    s_mov_b32 s9, s40
    s_atomic_add s9, s[12:13], 0 glc
    s_mov_b32 s5, 2
L_chret:
    s_setpc_b64 s[14:15]
L_chout:
    s_mov_b32 s4, 3
    s_mov_b32 s5, 0
    s_mov_b32 s7, 1
    s_setpc_b64 s[14:15]
L_grant:
    s_waitcnt lgkmcnt(0)
    s_add_u32 s9, s9, s93
    s_add_u32 s76, s9, s40
    s_min_u32 s76, s76, 2048
    s_sub_u32 s77, s9, s82
    s_sub_u32 s76, s76, s77
    s_cmp_ge_u32 s9, 2048
    s_cselect_b32 s76, -1, s76
    v_mov_b32 v50, s77
    v_mov_b32 v51, s76
    v_mov_b32 v52, s74
    s_mov_b64 exec, 1
    ds_write_b64 v52, v[50:51] offset:20488
    s_mov_b64 exec, -1
    s_setpc_b64 s[14:15]
L_switch:
    s_mov_b32 s1, 1
    v_add_f32_dpp v11, v11, v11 row_ror:8 row_mask:0xf bank_mask:0xf
    s_mul_i32 s76, s3, 3072
    v_lshl_add_u32 v46, v0, 4, s76
    s_lshl_b32 s77, s3, 3
    v_mov_b32 v47, s77
    v_mov_b32 v44, v11
    s_nop 1
    v_permlane16_swap_b32 v11, v44
    v_add_f32 v11, v11, v44
    v_mov_b32 v44, v11
    s_nop 1
    v_permlane32_swap_b32 v11, v44
    v_add_f32 v11, v11, v44
    v_mov_b32 v44, s71
    v_mov_b32 v45, v11
    ds_write_b128 v46, v[24:27] offset:28672
    ds_write_b128 v46, v[28:31] offset:29696
    ds_write_b128 v46, v[32:35] offset:30720
    s_mov_b64 exec, 1
    ds_write_b64 v47, v[44:45] offset:12320
    s_mov_b64 exec, -1
    v_and_b32 v49, 1, v0
    v_bfe_u32 v48, v0, 1, 3
    v_lshlrev_b32 v48, 4, v48
    v_lshl_add_u32 v49, v49, 8, v48
    v_lshrrev_b32 v48, 4, v0
    v_min_u32 v48, 2, v48
    v_lshl_add_u32 v49, v48, 10, v49
    v_mov_b32 v48, 0
    s_waitcnt lgkmcnt(0)
    s_mov_b64 exec, 1
    ds_add_rtn_u32 v44, v94, v93 offset:12
    s_mov_b64 exec, -1
    s_waitcnt lgkmcnt(0)
    v_readfirstlane_b32 s76, v44
    s_nop 0
    s_cmp_lg_u32 s76, 3
    s_cbranch_scc1 L_sw_nopub
    ds_read_b128 v[50:53], v48 offset:12320
    ds_read_b128 v[54:57], v48 offset:12336
    ds_read_b128 v[64:67], v49 offset:28672
    ds_read_b128 v[68:71], v49 offset:29312
    ds_read_b128 v[72:75], v49 offset:31744
    ds_read_b128 v[76:79], v49 offset:32384
    s_lshl_b32 s76, s86, 10
    s_add_u32 s76, s76, 2490368
    v_lshlrev_b32 v44, 4, v0
    v_cmp_eq_u32 vcc, 48, v0
    s_waitcnt lgkmcnt(4)
    v_max3_f32 v58, v50, v52, v54
    v_max_f32 v58, v58, v56
    v_mul_f32 v50, v9, v50
    v_mul_f32 v52, v9, v52
    v_mul_f32 v54, v9, v54
    v_mul_f32 v56, v9, v56
    v_mul_f32 v45, v9, v58
    v_max_f32 v45, 0xff7fffff, v45
    v_sub_f32 v50, v50, v45
    v_sub_f32 v52, v52, v45
    v_sub_f32 v54, v54, v45
    v_sub_f32 v56, v56, v45
    v_exp_f32 v50, v50
    v_exp_f32 v52, v52
    v_exp_f32 v54, v54
    v_exp_f32 v56, v56
    s_waitcnt lgkmcnt(2)
    v_pk_add_f32 v[64:65], v[64:65], v[68:69]
    v_pk_add_f32 v[66:67], v[66:67], v[70:71]
    v_mul_f32 v59, v50, v51
    v_pk_mul_f32 v[60:61], v[64:65], v[50:51] op_sel:[0,0] op_sel_hi:[1,0]
    v_pk_mul_f32 v[62:63], v[66:67], v[50:51] op_sel:[0,0] op_sel_hi:[1,0]
    ds_read_b128 v[64:67], v49 offset:34816
    ds_read_b128 v[68:71], v49 offset:35456
    s_waitcnt lgkmcnt(2)
    v_pk_add_f32 v[72:73], v[72:73], v[76:77]
    v_pk_add_f32 v[74:75], v[74:75], v[78:79]
    v_fmac_f32 v59, v52, v53
    v_pk_fma_f32 v[60:61], v[72:73], v[52:53], v[60:61] op_sel:[0,0,0] op_sel_hi:[1,0,1]
    v_pk_fma_f32 v[62:63], v[74:75], v[52:53], v[62:63] op_sel:[0,0,0] op_sel_hi:[1,0,1]
    ds_read_b128 v[72:75], v49 offset:37888
    ds_read_b128 v[76:79], v49 offset:38528
    s_waitcnt lgkmcnt(2)
    v_pk_add_f32 v[64:65], v[64:65], v[68:69]
    v_pk_add_f32 v[66:67], v[66:67], v[70:71]
    v_fmac_f32 v59, v54, v55
    v_pk_fma_f32 v[60:61], v[64:65], v[54:55], v[60:61] op_sel:[0,0,0] op_sel_hi:[1,0,1]
    v_pk_fma_f32 v[62:63], v[66:67], v[54:55], v[62:63] op_sel:[0,0,0] op_sel_hi:[1,0,1]
    s_waitcnt lgkmcnt(0)
    v_pk_add_f32 v[72:73], v[72:73], v[76:77]
    v_pk_add_f32 v[74:75], v[74:75], v[78:79]
    v_fmac_f32 v59, v56, v57
    v_pk_fma_f32 v[60:61], v[72:73], v[56:57], v[60:61] op_sel:[0,0,0] op_sel_hi:[1,0,1]
    v_pk_fma_f32 v[62:63], v[74:75], v[56:57], v[62:63] op_sel:[0,0,0] op_sel_hi:[1,0,1]
    v_cndmask_b32 v60, v60, v58, vcc
    v_cndmask_b32 v61, v61, v59, vcc
    v_bfi_b32 v60, v8, s64, v60
    v_bfi_b32 v61, v8, s65, v61
    v_bfi_b32 v62, v8, s66, v62
    v_bfi_b32 v63, v8, s67, v63
    s_mov_b32 exec_lo, 0xffffffff
    s_mov_b32 exec_hi, 0x1ffff
    buffer_store_dwordx4 v[60:63], v44, s[52:55], s76 offen sc1
    s_mov_b64 exec, -1
L_sw_nopub:
    s_mov_b32 s75, 0
L_lf10:
    ds_read_b32 v44, v94 offset:8
    s_add_u32 s75, s75, 1
    s_cmp_gt_u32 s75, 16777216
    s_cbranch_scc1 L_done
    s_waitcnt lgkmcnt(0)
    v_cmp_ne_u32 vcc, 0, v44
    s_cbranch_vccz L_lf10
    v_lshlrev_b32 v44, 4, v2
    ds_read_b128 v[12:15], v44 offset:19968
    ds_read_b128 v[16:19], v44 offset:20096
    ds_read_b128 v[20:23], v44 offset:20224
    v_mov_b32 v24, 0
    v_mov_b32 v25, 0
    v_mov_b32 v26, 0
    v_mov_b32 v27, 0
    v_mov_b32 v28, 0
    v_mov_b32 v29, 0
    v_mov_b32 v30, 0
    v_mov_b32 v31, 0
    v_mov_b32 v32, 0
    v_mov_b32 v33, 0
    v_mov_b32 v34, 0
    v_mov_b32 v35, 0
    v_mov_b32 v11, 0
    s_mov_b32 s71, 0xff800000
    s_mov_b32 s72, 0xff800000
    s_cmp_eq_u32 s81, 3
    s_cselect_b32 s81, 2, s81
    s_cselect_b32 s10, 6, s10
    s_mov_b64 exec, 0
    s_branch L_hop_comb_0
L_hopret_comb:
    s_mov_b64 exec, -1
    s_waitcnt lgkmcnt(0)
    s_setpc_b64 s[14:15]
L_event:
    s_cmp_eq_u32 s81, 1
    s_cbranch_scc1 L_ftr
    s_cmp_eq_u32 s81, 2
    s_cbranch_scc1 L_wmerge
    s_cmp_eq_u32 s70, 1
    s_cbranch_scc0 L_fload
    s_cmp_ge_u32 s3, 2
    s_cselect_b32 s81, 3, 4
    s_mov_b32 s56, s24
    s_mov_b32 s57, s25
    s_mov_b32 s58, 7864320
    s_mov_b32 s59, 0x20000
    v_mul_u32_u24 v54, 7680, v1
    v_lshl_add_u32 v54, v2, 4, v54
    s_mul_i32 s78, s3, 61440
    s_lshl_b32 s79, s89, 7
    s_add_u32 s78, s78, s79
    s_lshl_b32 s76, s88, 1
    s_sub_u32 s76, s76, 2
    s_cmp_eq_u32 s88, 0
    s_cselect_b32 s76, 20, s76
    s_mul_i32 s76, s76, 245760
    s_add_u32 s76, s76, s78
    s_add_u32 s77, s76, 5120
    buffer_load_dwordx4 a[144:147], v54, s[56:59], s76 offen offset:0 nt
    buffer_load_dwordx4 a[148:151], v54, s[56:59], s76 offen offset:1280 nt
    buffer_load_dwordx4 a[152:155], v54, s[56:59], s76 offen offset:2560 nt
    buffer_load_dwordx4 a[156:159], v54, s[56:59], s76 offen offset:3840 nt
    buffer_load_dwordx4 a[160:163], v54, s[56:59], s77 offen offset:0 nt
    buffer_load_dwordx4 a[164:167], v54, s[56:59], s77 offen offset:1280 nt
    s_lshl_b32 s76, s88, 1
    s_sub_u32 s76, s76, 1
    s_cmp_eq_u32 s88, 0
    s_cselect_b32 s76, 20, s76
    s_mul_i32 s76, s76, 245760
    s_add_u32 s76, s76, s78
    s_add_u32 s77, s76, 5120
    buffer_load_dwordx4 a[168:171], v54, s[56:59], s76 offen offset:0 nt
    buffer_load_dwordx4 a[172:175], v54, s[56:59], s76 offen offset:1280 nt
    buffer_load_dwordx4 a[176:179], v54, s[56:59], s76 offen offset:2560 nt
    buffer_load_dwordx4 a[180:183], v54, s[56:59], s76 offen offset:3840 nt
    buffer_load_dwordx4 a[184:187], v54, s[56:59], s77 offen offset:0 nt
    buffer_load_dwordx4 a[188:191], v54, s[56:59], s77 offen offset:1280 nt
    s_add_u32 s76, s88, 21
    s_mul_i32 s76, s76, 245760
    s_add_u32 s76, s76, s78
    s_add_u32 s77, s76, 5120
    buffer_load_dwordx4 a[192:195], v54, s[56:59], s76 offen offset:0 nt
    buffer_load_dwordx4 a[196:199], v54, s[56:59], s76 offen offset:1280 nt
    buffer_load_dwordx4 a[200:203], v54, s[56:59], s76 offen offset:2560 nt
    buffer_load_dwordx4 a[204:207], v54, s[56:59], s76 offen offset:3840 nt
    buffer_load_dwordx4 a[208:211], v54, s[56:59], s77 offen offset:0 nt
    buffer_load_dwordx4 a[212:215], v54, s[56:59], s77 offen offset:1280 nt
L_wret:
    s_setpc_b64 s[14:15]
L_fload:
    s_mov_b32 s81, 1
    s_mov_b32 s10, 2
    v_cmp_gt_u32 vcc, 4, v2
    v_mov_b32 v54, s30
    v_mov_b32 v55, s28
    v_cndmask_b32 v54, v54, v55, vcc
    v_mov_b32 v55, s31
    v_mov_b32 v56, s29
    v_cndmask_b32 v55, v55, v56, vcc
    s_mul_i32 s76, s3, 491520
    s_lshl_b32 s77, s88, 6
    s_add_u32 s76, s76, s77
    v_mul_u32_u24 v56, 3072, v1
    v_and_b32 v57, 3, v2
    v_lshl_add_u32 v56, v57, 4, v56
    v_add_u32 v56, s76, v56
    v_mov_b32 v57, 0
    v_lshl_add_u64 v[54:55], v[56:57], 0, v[54:55]
    s_mov_b32 s76, 24576
    s_mov_b32 s77, 0
    global_load_dwordx4 a[144:147], v[54:55], off nt
    v_lshl_add_u64 v[54:55], v[54:55], 0, s[76:77]
    global_load_dwordx4 a[148:151], v[54:55], off nt
    v_lshl_add_u64 v[54:55], v[54:55], 0, s[76:77]
    global_load_dwordx4 a[152:155], v[54:55], off nt
    v_lshl_add_u64 v[54:55], v[54:55], 0, s[76:77]
    global_load_dwordx4 a[156:159], v[54:55], off nt
    v_lshl_add_u64 v[54:55], v[54:55], 0, s[76:77]
    global_load_dwordx4 a[160:163], v[54:55], off nt
    v_lshl_add_u64 v[54:55], v[54:55], 0, s[76:77]
    global_load_dwordx4 a[164:167], v[54:55], off nt
    v_lshl_add_u64 v[54:55], v[54:55], 0, s[76:77]
    global_load_dwordx4 a[168:171], v[54:55], off nt
    v_lshl_add_u64 v[54:55], v[54:55], 0, s[76:77]
    global_load_dwordx4 a[172:175], v[54:55], off nt
    v_lshl_add_u64 v[54:55], v[54:55], 0, s[76:77]
    global_load_dwordx4 a[176:179], v[54:55], off nt
    v_lshl_add_u64 v[54:55], v[54:55], 0, s[76:77]
    global_load_dwordx4 a[180:183], v[54:55], off nt
    v_lshl_add_u64 v[54:55], v[54:55], 0, s[76:77]
    global_load_dwordx4 a[184:187], v[54:55], off nt
    v_lshl_add_u64 v[54:55], v[54:55], 0, s[76:77]
    global_load_dwordx4 a[188:191], v[54:55], off nt
    v_lshl_add_u64 v[54:55], v[54:55], 0, s[76:77]
    global_load_dwordx4 a[192:195], v[54:55], off nt
    v_lshl_add_u64 v[54:55], v[54:55], 0, s[76:77]
    global_load_dwordx4 a[196:199], v[54:55], off nt
    v_lshl_add_u64 v[54:55], v[54:55], 0, s[76:77]
    global_load_dwordx4 a[200:203], v[54:55], off nt
    v_lshl_add_u64 v[54:55], v[54:55], 0, s[76:77]
    global_load_dwordx4 a[204:207], v[54:55], off nt
    v_lshl_add_u64 v[54:55], v[54:55], 0, s[76:77]
    global_load_dwordx4 a[208:211], v[54:55], off nt
    v_lshl_add_u64 v[54:55], v[54:55], 0, s[76:77]
    global_load_dwordx4 a[212:215], v[54:55], off nt
    v_lshl_add_u64 v[54:55], v[54:55], 0, s[76:77]
    global_load_dwordx4 a[216:219], v[54:55], off nt
    v_lshl_add_u64 v[54:55], v[54:55], 0, s[76:77]
    global_load_dwordx4 a[220:223], v[54:55], off nt
    s_mov_b32 s56, s32
    s_mov_b32 s57, s33
    s_mov_b32 s58, 1966080
    s_mov_b32 s59, 0x20000
    s_mul_i32 s76, s88, 40960
    s_lshl_b32 s77, s3, 7
    s_add_u32 s76, s76, s77
    s_add_u32 s77, s76, 10240
    s_add_u32 s78, s77, 10240
    s_add_u32 s79, s78, 10240
    v_mul_u32_u24 v54, 1280, v1
    v_lshl_add_u32 v54, v2, 4, v54
    buffer_load_dwordx4 a[224:227], v54, s[56:59], s76 offen offset:0 nt
    buffer_load_dwordx4 a[228:231], v54, s[56:59], s77 offen offset:0 nt
    buffer_load_dwordx4 a[232:235], v54, s[56:59], s78 offen offset:0 nt
    buffer_load_dwordx4 a[236:239], v54, s[56:59], s79 offen offset:0 nt
    buffer_load_dwordx4 a[240:243], v54, s[56:59], s76 offen offset:512 nt
    buffer_load_dwordx4 a[244:247], v54, s[56:59], s77 offen offset:512 nt
    buffer_load_dwordx4 a[248:251], v54, s[56:59], s78 offen offset:512 nt
    buffer_load_dwordx4 a[252:255], v54, s[56:59], s79 offen offset:512 nt
    s_cmp_ge_u32 s3, 2
    s_cbranch_scc1 L_floaded
    buffer_load_dwordx4 v[240:243], v54, s[56:59], s76 offen offset:1024 nt
    buffer_load_dwordx4 v[244:247], v54, s[56:59], s77 offen offset:1024 nt
    buffer_load_dwordx4 v[248:251], v54, s[56:59], s78 offen offset:1024 nt
    buffer_load_dwordx4 v[252:255], v54, s[56:59], s79 offen offset:1024 nt
L_floaded:
    s_setpc_b64 s[14:15]
L_ftr:
    s_lshl_b32 s81, s81, 2
    s_lshl_b32 s76, s3, 12
    v_lshl_add_u32 v54, v0, 4, s76
    v_lshrrev_b32 v55, 4, v0
    v_lshlrev_b32 v55, 10, v55
    v_bfe_u32 v56, v0, 2, 2
    v_lshl_add_u32 v55, v56, 7, v55
    v_and_b32 v56, 3, v0
    v_lshl_add_u32 v55, v56, 3, v55
    v_add_u32 v55, s76, v55
    ds_write_b128 v54, a[144:147] offset:40960
    ds_write_b128 v54, a[148:151] offset:41984
    ds_write_b128 v54, a[152:155] offset:43008
    ds_write_b128 v54, a[156:159] offset:44032
    s_waitcnt lgkmcnt(0)
    ds_read_b64_tr_b16 a[144:145], v55 offset:40960
    ds_read_b64_tr_b16 a[146:147], v55 offset:41472
    ds_read_b64_tr_b16 a[148:149], v55 offset:40992
    ds_read_b64_tr_b16 a[150:151], v55 offset:41504
    ds_read_b64_tr_b16 a[152:153], v55 offset:41024
    ds_read_b64_tr_b16 a[154:155], v55 offset:41536
    ds_read_b64_tr_b16 a[156:157], v55 offset:41056
    ds_read_b64_tr_b16 a[158:159], v55 offset:41568
    s_waitcnt lgkmcnt(0)
    ds_write_b128 v54, a[160:163] offset:40960
    ds_write_b128 v54, a[164:167] offset:41984
    ds_write_b128 v54, a[168:171] offset:43008
    ds_write_b128 v54, a[172:175] offset:44032
    s_waitcnt lgkmcnt(0)
    ds_read_b64_tr_b16 a[160:161], v55 offset:40960
    ds_read_b64_tr_b16 a[162:163], v55 offset:41472
    ds_read_b64_tr_b16 a[164:165], v55 offset:40992
    ds_read_b64_tr_b16 a[166:167], v55 offset:41504
    ds_read_b64_tr_b16 a[168:169], v55 offset:41024
    ds_read_b64_tr_b16 a[170:171], v55 offset:41536
    ds_read_b64_tr_b16 a[172:173], v55 offset:41056
    ds_read_b64_tr_b16 a[174:175], v55 offset:41568
    s_waitcnt lgkmcnt(0)
    ds_write_b128 v54, a[176:179] offset:40960
    ds_write_b128 v54, a[180:183] offset:41984
    ds_write_b128 v54, a[184:187] offset:43008
    ds_write_b128 v54, a[188:191] offset:44032
    s_waitcnt lgkmcnt(0)
    ds_read_b64_tr_b16 a[176:177], v55 offset:40960
    ds_read_b64_tr_b16 a[178:179], v55 offset:41472
    ds_read_b64_tr_b16 a[180:181], v55 offset:40992
    ds_read_b64_tr_b16 a[182:183], v55 offset:41504
    ds_read_b64_tr_b16 a[184:185], v55 offset:41024
    ds_read_b64_tr_b16 a[186:187], v55 offset:41536
    ds_read_b64_tr_b16 a[188:189], v55 offset:41056
    ds_read_b64_tr_b16 a[190:191], v55 offset:41568
    s_waitcnt lgkmcnt(0)
    ds_write_b128 v54, a[192:195] offset:40960
    ds_write_b128 v54, a[196:199] offset:41984
    ds_write_b128 v54, a[200:203] offset:43008
    ds_write_b128 v54, a[204:207] offset:44032
    s_waitcnt lgkmcnt(0)
    ds_read_b64_tr_b16 a[192:193], v55 offset:40960
    ds_read_b64_tr_b16 a[194:195], v55 offset:41472
    ds_read_b64_tr_b16 a[196:197], v55 offset:40992
    ds_read_b64_tr_b16 a[198:199], v55 offset:41504
    ds_read_b64_tr_b16 a[200:201], v55 offset:41024
    ds_read_b64_tr_b16 a[202:203], v55 offset:41536
    ds_read_b64_tr_b16 a[204:205], v55 offset:41056
    ds_read_b64_tr_b16 a[206:207], v55 offset:41568
    s_waitcnt lgkmcnt(0)
    ds_write_b128 v54, a[208:211] offset:40960
    ds_write_b128 v54, a[212:215] offset:41984
    ds_write_b128 v54, a[216:219] offset:43008
    ds_write_b128 v54, a[220:223] offset:44032
    s_waitcnt lgkmcnt(0)
    ds_read_b64_tr_b16 a[208:209], v55 offset:40960
    ds_read_b64_tr_b16 a[210:211], v55 offset:41472
    ds_read_b64_tr_b16 a[212:213], v55 offset:40992
    ds_read_b64_tr_b16 a[214:215], v55 offset:41504
    ds_read_b64_tr_b16 a[216:217], v55 offset:41024
    ds_read_b64_tr_b16 a[218:219], v55 offset:41536
    ds_read_b64_tr_b16 a[220:221], v55 offset:41056
    ds_read_b64_tr_b16 a[222:223], v55 offset:41568
    s_waitcnt lgkmcnt(0)
    ds_write_b128 v54, a[224:227] offset:40960
    ds_write_b128 v54, a[228:231] offset:41984
    ds_write_b128 v54, a[232:235] offset:43008
    ds_write_b128 v54, a[236:239] offset:44032
    s_waitcnt lgkmcnt(0)
    ds_read_b64_tr_b16 a[224:225], v55 offset:40960
    ds_read_b64_tr_b16 a[226:227], v55 offset:41472
    ds_read_b64_tr_b16 a[228:229], v55 offset:40992
    ds_read_b64_tr_b16 a[230:231], v55 offset:41504
    ds_read_b64_tr_b16 a[232:233], v55 offset:41024
    ds_read_b64_tr_b16 a[234:235], v55 offset:41536
    ds_read_b64_tr_b16 a[236:237], v55 offset:41056
    ds_read_b64_tr_b16 a[238:239], v55 offset:41568
    s_waitcnt lgkmcnt(0)
    ds_write_b128 v54, a[240:243] offset:40960
    ds_write_b128 v54, a[244:247] offset:41984
    ds_write_b128 v54, a[248:251] offset:43008
    ds_write_b128 v54, a[252:255] offset:44032
    s_waitcnt lgkmcnt(0)
    ds_read_b64_tr_b16 a[240:241], v55 offset:40960
    ds_read_b64_tr_b16 a[242:243], v55 offset:41472
    ds_read_b64_tr_b16 a[244:245], v55 offset:40992
    ds_read_b64_tr_b16 a[246:247], v55 offset:41504
    ds_read_b64_tr_b16 a[248:249], v55 offset:41024
    ds_read_b64_tr_b16 a[250:251], v55 offset:41536
    ds_read_b64_tr_b16 a[252:253], v55 offset:41056
    ds_read_b64_tr_b16 a[254:255], v55 offset:41568
    s_waitcnt lgkmcnt(0)
    s_cmp_ge_u32 s3, 2
    s_cbranch_scc1 L_ftrd
    ds_write_b128 v54, v[240:243] offset:40960
    ds_write_b128 v54, v[244:247] offset:41984
    ds_write_b128 v54, v[248:251] offset:43008
    ds_write_b128 v54, v[252:255] offset:44032
    s_waitcnt lgkmcnt(0)
    ds_read_b64_tr_b16 v[240:241], v55 offset:40960
    ds_read_b64_tr_b16 v[242:243], v55 offset:41472
    ds_read_b64_tr_b16 v[244:245], v55 offset:40992
    ds_read_b64_tr_b16 v[246:247], v55 offset:41504
    ds_read_b64_tr_b16 v[248:249], v55 offset:41024
    ds_read_b64_tr_b16 v[250:251], v55 offset:41536
    ds_read_b64_tr_b16 v[252:253], v55 offset:41056
    ds_read_b64_tr_b16 v[254:255], v55 offset:41568
    s_waitcnt lgkmcnt(0)
L_ftrd:
    s_setpc_b64 s[14:15]
L_wmerge:
    s_lshl_b32 s81, s81, 1
    v_min_u32 v44, 47, v0
    v_lshlrev_b32 v44, 4, v44
    s_lshl1_add_u32 s76, s88, s3
    s_sub_u32 s76, s76, 4
    s_add_u32 s77, s3, 18
    s_cmp_eq_u32 s88, 0
    s_cselect_b32 s76, s77, s76
    s_cmp_eq_u32 s76, 21
    s_cselect_b32 s77, 4, 12
    s_sub_u32 s78, s77, 1
    s_mul_i32 s76, s76, 12288
    s_add_u32 s76, s76, 2490368
    s_mov_b32 s80, 0
    v_mov_b32 v46, s77
    v_subrev_u32 v46, 1, v46
    v_and_b32 v45, 31, v0
    v_cmp_gt_u32 s[90:91], s77, v45
    v_min_u32 v45, v46, v45
    v_lshlrev_b32 v45, 10, v45
    s_add_u32 s79, s80, 0
    s_min_u32 s16, s79, s78
    s_lshl_b32 s16, s16, 10
    s_add_u32 s16, s16, s76
    s_add_u32 s79, s80, 1
    s_min_u32 s17, s79, s78
    s_lshl_b32 s17, s17, 10
    s_add_u32 s17, s17, s76
    s_add_u32 s79, s80, 2
    s_min_u32 s18, s79, s78
    s_lshl_b32 s18, s18, 10
    s_add_u32 s18, s18, s76
    s_add_u32 s79, s80, 3
    s_min_u32 s19, s79, s78
    s_lshl_b32 s19, s19, 10
    s_add_u32 s19, s19, s76
    s_add_u32 s79, s80, 4
    s_min_u32 s20, s79, s78
    s_lshl_b32 s20, s20, 10
    s_add_u32 s20, s20, s76
    s_add_u32 s79, s80, 5
    s_min_u32 s21, s79, s78
    s_lshl_b32 s21, s21, 10
    s_add_u32 s21, s21, s76
    s_mov_b32 s75, 0
L_poll11:
    buffer_load_dwordx4 v[56:59], v45, s[52:55], s76 offen offset:768 sc1
    buffer_load_dwordx4 v[64:67], v44, s[52:55], s16 offen sc1
    buffer_load_dwordx4 v[68:71], v44, s[52:55], s17 offen sc1
    buffer_load_dwordx4 v[72:75], v44, s[52:55], s18 offen sc1
    buffer_load_dwordx4 v[76:79], v44, s[52:55], s19 offen sc1
    buffer_load_dwordx4 v[80:83], v44, s[52:55], s20 offen sc1
    buffer_load_dwordx4 v[84:87], v44, s[52:55], s21 offen sc1
    s_add_u32 s75, s75, 1
    s_cmp_gt_u32 s75, 2097152
    s_cbranch_scc1 L_done
    s_waitcnt vmcnt(6)
    v_xor_b32 v56, s64, v56
    v_xor_b32 v57, s65, v57
    v_xor_b32 v58, s66, v58
    v_xor_b32 v59, s67, v59
    v_or3_b32 v46, v56, v57, v58
    v_or_b32 v46, v46, v59
    s_waitcnt vmcnt(5)
    v_xor_b32 v64, s64, v64
    v_xor_b32 v65, s65, v65
    v_xor_b32 v66, s66, v66
    v_xor_b32 v67, s67, v67
    v_or3_b32 v46, v64, v65, v46
    v_or3_b32 v46, v66, v67, v46
    s_waitcnt vmcnt(4)
    v_xor_b32 v68, s64, v68
    v_xor_b32 v69, s65, v69
    v_xor_b32 v70, s66, v70
    v_xor_b32 v71, s67, v71
    v_or3_b32 v46, v68, v69, v46
    v_or3_b32 v46, v70, v71, v46
    s_waitcnt vmcnt(3)
    v_xor_b32 v72, s64, v72
    v_xor_b32 v73, s65, v73
    v_xor_b32 v74, s66, v74
    v_xor_b32 v75, s67, v75
    v_or3_b32 v46, v72, v73, v46
    v_or3_b32 v46, v74, v75, v46
    s_waitcnt vmcnt(2)
    v_xor_b32 v76, s64, v76
    v_xor_b32 v77, s65, v77
    v_xor_b32 v78, s66, v78
    v_xor_b32 v79, s67, v79
    v_or3_b32 v46, v76, v77, v46
    v_or3_b32 v46, v78, v79, v46
    s_waitcnt vmcnt(1)
    v_xor_b32 v80, s64, v80
    v_xor_b32 v81, s65, v81
    v_xor_b32 v82, s66, v82
    v_xor_b32 v83, s67, v83
    v_or3_b32 v46, v80, v81, v46
    v_or3_b32 v46, v82, v83, v46
    s_waitcnt vmcnt(0)
    v_xor_b32 v84, s64, v84
    v_xor_b32 v85, s65, v85
    v_xor_b32 v86, s66, v86
    v_xor_b32 v87, s67, v87
    v_or3_b32 v46, v84, v85, v46
    v_or3_b32 v46, v86, v87, v46
    v_and_b32 v46, v8, v46
    v_cmp_ne_u32 vcc, 0, v46
    s_cbranch_vccnz L_poll11
    v_mul_f32 v56, v9, v56
    v_mov_b32 v46, 0xff800000
    v_cndmask_b32 v56, v46, v56, s[90:91]
    v_mov_b32 v54, v56
    s_nop 1
    v_max_f32_dpp v54, v54, v54 quad_perm:[1,0,3,2] row_mask:0xf bank_mask:0xf
    s_nop 1
    v_max_f32_dpp v54, v54, v54 quad_perm:[2,3,0,1] row_mask:0xf bank_mask:0xf
    s_nop 1
    v_max_f32_dpp v54, v54, v54 row_half_mirror row_mask:0xf bank_mask:0xf
    s_nop 1
    v_max_f32_dpp v54, v54, v54 row_ror:8 row_mask:0xf bank_mask:0xf
    v_mov_b32 v46, v54
    s_nop 1
    v_permlane16_swap_b32 v54, v46
    v_max_f32 v54, v54, v46
    v_sub_f32 v56, v56, v54
    v_exp_f32 v56, v56
    s_nop 0
    v_mul_f32 v57, v57, v56
    v_readlane_b32 s16, v56, 0
    v_readlane_b32 s17, v56, 1
    v_readlane_b32 s18, v56, 2
    v_readlane_b32 s19, v56, 3
    v_readlane_b32 s20, v56, 4
    v_readlane_b32 s21, v56, 5
    v_readlane_b32 s22, v56, 6
    v_readlane_b32 s23, v56, 7
    v_readlane_b32 s24, v56, 8
    v_readlane_b32 s25, v56, 9
    v_readlane_b32 s26, v56, 10
    v_readlane_b32 s27, v56, 11
    v_add_f32_dpp v57, v57, v57 quad_perm:[1,0,3,2] row_mask:0xf bank_mask:0xf
    s_nop 1
    v_add_f32_dpp v57, v57, v57 quad_perm:[2,3,0,1] row_mask:0xf bank_mask:0xf
    s_nop 1
    v_add_f32_dpp v57, v57, v57 row_half_mirror row_mask:0xf bank_mask:0xf
    s_nop 1
    v_add_f32_dpp v57, v57, v57 row_ror:8 row_mask:0xf bank_mask:0xf
    v_mov_b32 v46, v57
    s_nop 1
    v_permlane16_swap_b32 v57, v46
    v_add_f32 v57, v57, v46
    v_pk_mul_f32 v[60:61], v[64:65], s[16:17] op_sel:[0,0] op_sel_hi:[1,0]
    v_pk_mul_f32 v[62:63], v[66:67], s[16:17] op_sel:[0,0] op_sel_hi:[1,0]
    v_pk_fma_f32 v[60:61], v[68:69], s[16:17], v[60:61] op_sel:[0,1,0] op_sel_hi:[1,1,1]
    v_pk_fma_f32 v[62:63], v[70:71], s[16:17], v[62:63] op_sel:[0,1,0] op_sel_hi:[1,1,1]
    v_pk_fma_f32 v[60:61], v[72:73], s[18:19], v[60:61] op_sel:[0,0,0] op_sel_hi:[1,0,1]
    v_pk_fma_f32 v[62:63], v[74:75], s[18:19], v[62:63] op_sel:[0,0,0] op_sel_hi:[1,0,1]
    v_pk_fma_f32 v[60:61], v[76:77], s[18:19], v[60:61] op_sel:[0,1,0] op_sel_hi:[1,1,1]
    v_pk_fma_f32 v[62:63], v[78:79], s[18:19], v[62:63] op_sel:[0,1,0] op_sel_hi:[1,1,1]
    v_pk_fma_f32 v[60:61], v[80:81], s[20:21], v[60:61] op_sel:[0,0,0] op_sel_hi:[1,0,1]
    v_pk_fma_f32 v[62:63], v[82:83], s[20:21], v[62:63] op_sel:[0,0,0] op_sel_hi:[1,0,1]
    v_pk_fma_f32 v[60:61], v[84:85], s[20:21], v[60:61] op_sel:[0,1,0] op_sel_hi:[1,1,1]
    v_pk_fma_f32 v[62:63], v[86:87], s[20:21], v[62:63] op_sel:[0,1,0] op_sel_hi:[1,1,1]
    s_mov_b32 s80, 6
    s_add_u32 s79, s80, 0
    s_min_u32 s16, s79, s78
    s_lshl_b32 s16, s16, 10
    s_add_u32 s16, s16, s76
    s_add_u32 s79, s80, 1
    s_min_u32 s17, s79, s78
    s_lshl_b32 s17, s17, 10
    s_add_u32 s17, s17, s76
    s_add_u32 s79, s80, 2
    s_min_u32 s18, s79, s78
    s_lshl_b32 s18, s18, 10
    s_add_u32 s18, s18, s76
    s_add_u32 s79, s80, 3
    s_min_u32 s19, s79, s78
    s_lshl_b32 s19, s19, 10
    s_add_u32 s19, s19, s76
    s_add_u32 s79, s80, 4
    s_min_u32 s20, s79, s78
    s_lshl_b32 s20, s20, 10
    s_add_u32 s20, s20, s76
    s_add_u32 s79, s80, 5
    s_min_u32 s21, s79, s78
    s_lshl_b32 s21, s21, 10
    s_add_u32 s21, s21, s76
    s_mov_b32 s75, 0
L_poll12:
    buffer_load_dwordx4 v[64:67], v44, s[52:55], s16 offen sc1
    buffer_load_dwordx4 v[68:71], v44, s[52:55], s17 offen sc1
    buffer_load_dwordx4 v[72:75], v44, s[52:55], s18 offen sc1
    buffer_load_dwordx4 v[76:79], v44, s[52:55], s19 offen sc1
    buffer_load_dwordx4 v[80:83], v44, s[52:55], s20 offen sc1
    buffer_load_dwordx4 v[84:87], v44, s[52:55], s21 offen sc1
    s_add_u32 s75, s75, 1
    s_cmp_gt_u32 s75, 2097152
    s_cbranch_scc1 L_done
    s_waitcnt vmcnt(5)
    v_xor_b32 v64, s64, v64
    v_xor_b32 v65, s65, v65
    v_xor_b32 v66, s66, v66
    v_xor_b32 v67, s67, v67
    v_or3_b32 v46, v64, v65, v66
    v_or_b32 v46, v46, v67
    s_waitcnt vmcnt(4)
    v_xor_b32 v68, s64, v68
    v_xor_b32 v69, s65, v69
    v_xor_b32 v70, s66, v70
    v_xor_b32 v71, s67, v71
    v_or3_b32 v46, v68, v69, v46
    v_or3_b32 v46, v70, v71, v46
    s_waitcnt vmcnt(3)
    v_xor_b32 v72, s64, v72
    v_xor_b32 v73, s65, v73
    v_xor_b32 v74, s66, v74
    v_xor_b32 v75, s67, v75
    v_or3_b32 v46, v72, v73, v46
    v_or3_b32 v46, v74, v75, v46
    s_waitcnt vmcnt(2)
    v_xor_b32 v76, s64, v76
    v_xor_b32 v77, s65, v77
    v_xor_b32 v78, s66, v78
    v_xor_b32 v79, s67, v79
    v_or3_b32 v46, v76, v77, v46
    v_or3_b32 v46, v78, v79, v46
    s_waitcnt vmcnt(1)
    v_xor_b32 v80, s64, v80
    v_xor_b32 v81, s65, v81
    v_xor_b32 v82, s66, v82
    v_xor_b32 v83, s67, v83
    v_or3_b32 v46, v80, v81, v46
    v_or3_b32 v46, v82, v83, v46
    s_waitcnt vmcnt(0)
    v_xor_b32 v84, s64, v84
    v_xor_b32 v85, s65, v85
    v_xor_b32 v86, s66, v86
    v_xor_b32 v87, s67, v87
    v_or3_b32 v46, v84, v85, v46
    v_or3_b32 v46, v86, v87, v46
    v_and_b32 v46, v8, v46
    v_cmp_ne_u32 vcc, 0, v46
    s_cbranch_vccnz L_poll12
    v_pk_fma_f32 v[60:61], v[64:65], s[22:23], v[60:61] op_sel:[0,0,0] op_sel_hi:[1,0,1]
    v_pk_fma_f32 v[62:63], v[66:67], s[22:23], v[62:63] op_sel:[0,0,0] op_sel_hi:[1,0,1]
    v_pk_fma_f32 v[60:61], v[68:69], s[22:23], v[60:61] op_sel:[0,1,0] op_sel_hi:[1,1,1]
    v_pk_fma_f32 v[62:63], v[70:71], s[22:23], v[62:63] op_sel:[0,1,0] op_sel_hi:[1,1,1]
    v_pk_fma_f32 v[60:61], v[72:73], s[24:25], v[60:61] op_sel:[0,0,0] op_sel_hi:[1,0,1]
    v_pk_fma_f32 v[62:63], v[74:75], s[24:25], v[62:63] op_sel:[0,0,0] op_sel_hi:[1,0,1]
    v_pk_fma_f32 v[60:61], v[76:77], s[24:25], v[60:61] op_sel:[0,1,0] op_sel_hi:[1,1,1]
    v_pk_fma_f32 v[62:63], v[78:79], s[24:25], v[62:63] op_sel:[0,1,0] op_sel_hi:[1,1,1]
    v_pk_fma_f32 v[60:61], v[80:81], s[26:27], v[60:61] op_sel:[0,0,0] op_sel_hi:[1,0,1]
    v_pk_fma_f32 v[62:63], v[82:83], s[26:27], v[62:63] op_sel:[0,0,0] op_sel_hi:[1,0,1]
    v_pk_fma_f32 v[60:61], v[84:85], s[26:27], v[60:61] op_sel:[0,1,0] op_sel_hi:[1,1,1]
    v_pk_fma_f32 v[62:63], v[86:87], s[26:27], v[62:63] op_sel:[0,1,0] op_sel_hi:[1,1,1]
    v_mov_b32 v64, 0
    v_mov_b32 v65, 0
    v_mov_b32 v66, 0
    v_mov_b32 v67, 0
    s_cmp_eq_u32 s77, 4
    s_cbranch_scc1 L_wpart
    v_rcp_f32 v57, v57
    s_mul_i32 s76, s3, 768
    v_pk_mul_f32 v[60:61], v[60:61], v[56:57] op_sel:[0,1] op_sel_hi:[1,1]
    v_pk_mul_f32 v[62:63], v[62:63], v[56:57] op_sel:[0,1] op_sel_hi:[1,1]
    v_cvt_pk_bf16_f32 v60, v60, v60
    v_cvt_pk_bf16_f32 v61, v61, v61
    v_cvt_pk_bf16_f32 v62, v62, v62
    v_cvt_pk_bf16_f32 v63, v63, v63
    v_add_u32 v46, s76, v44
    ds_write_b128 v46, v[60:63] offset:11776
    s_cmp_eq_u32 s3, 3
    s_cbranch_scc0 L_wpe
    v_mov_b32 v46, 0xff800000
    v_mov_b32 v47, 0
    ds_write_b128 v44, v[64:67] offset:14912
    ds_write_b64 v64, v[46:47] offset:14848
    s_branch L_wpe
L_wpart:
    v_mov_b32 v46, v54
    v_mov_b32 v47, v57
    ds_write_b128 v44, v[64:67] offset:14080
    ds_write_b128 v44, v[60:63] offset:14912
    ds_write_b64 v64, v[46:47] offset:14848
L_wpe:
    s_waitcnt lgkmcnt(0)
    s_setpc_b64 s[14:15]
L_end:
L_hop_comb_0:
    s_cbranch_execz L_hop_comb_1
    s_cmp_lg_u32 s1, 0
L_hop_comb_1:
    s_cbranch_execz L_hop_comb_2
    s_cbranch_scc1 L_swdone
    s_call_b64 s[14:15], L_switch
L_swdone:
L_evl:
    s_cmp_eq_u32 s81, 4
    s_cbranch_scc1 L_wdone
    s_cmp_eq_u32 s81, 3
    s_cselect_b32 s81, 2, s81
    s_waitcnt vmcnt(0)
    s_call_b64 s[14:15], L_event
    s_branch L_evl
L_wdone:
    v_add_f32_dpp v11, v11, v11 row_ror:8 row_mask:0xf bank_mask:0xf
    s_mul_i32 s76, s3, 3072
    v_lshl_add_u32 v46, v0, 4, s76
    s_lshl_b32 s77, s3, 3
    v_mov_b32 v47, s77
    v_mov_b32 v44, v11
    s_nop 1
    v_permlane16_swap_b32 v11, v44
    v_add_f32 v11, v11, v44
    v_mov_b32 v44, v11
    s_nop 1
    v_permlane32_swap_b32 v11, v44
    v_add_f32 v11, v11, v44
    v_mov_b32 v44, s71
    v_mov_b32 v45, v11
    ds_write_b128 v46, v[24:27] offset:0
    ds_write_b128 v46, v[28:31] offset:1024
    ds_write_b128 v46, v[32:35] offset:2048
    s_mov_b64 exec, 1
    ds_write_b64 v47, v[44:45] offset:12288
    s_mov_b64 exec, -1
    v_and_b32 v49, 1, v0
    v_bfe_u32 v48, v0, 1, 3
    v_lshlrev_b32 v48, 4, v48
    v_lshl_add_u32 v49, v49, 8, v48
    v_lshrrev_b32 v48, 4, v0
    v_min_u32 v48, 2, v48
    v_lshl_add_u32 v49, v48, 10, v49
    v_mov_b32 v48, 0
    s_waitcnt lgkmcnt(0)
    s_barrier
    s_cmp_lg_u32 s3, 0
    s_cbranch_scc1 L_opub
    ds_read_b128 v[50:53], v48 offset:12288
    ds_read_b128 v[54:57], v48 offset:12304
    ds_read_b128 v[96:99], v49 offset:0
    ds_read_b128 v[100:103], v49 offset:640
    ds_read_b128 v[104:107], v49 offset:3072
L_hop_comb_2:
    s_cbranch_execz L_hop_comb_3
    ds_read_b128 v[108:111], v49 offset:3712
    ds_read_b128 v[112:115], v49 offset:6144
    ds_read_b128 v[116:119], v49 offset:6784
    ds_read_b128 v[120:123], v49 offset:9216
    ds_read_b128 v[124:127], v49 offset:9856
    s_lshl_b32 s76, s87, 10
    s_add_u32 s76, s76, 2097152
    v_lshlrev_b32 v44, 4, v0
    v_cmp_eq_u32 vcc, 48, v0
    s_waitcnt lgkmcnt(8)
    v_max3_f32 v58, v50, v52, v54
    v_max_f32 v58, v58, v56
    v_mul_f32 v50, v9, v50
    v_mul_f32 v52, v9, v52
    v_mul_f32 v54, v9, v54
    v_mul_f32 v56, v9, v56
    v_mul_f32 v45, v9, v58
    v_max_f32 v45, 0xff7fffff, v45
    v_sub_f32 v50, v50, v45
    v_sub_f32 v52, v52, v45
    v_sub_f32 v54, v54, v45
    v_sub_f32 v56, v56, v45
    v_exp_f32 v50, v50
    v_exp_f32 v52, v52
    v_exp_f32 v54, v54
    v_exp_f32 v56, v56
    s_waitcnt lgkmcnt(6)
    v_pk_add_f32 v[96:97], v[96:97], v[100:101]
    v_pk_add_f32 v[98:99], v[98:99], v[102:103]
    v_mul_f32 v59, v50, v51
    v_pk_mul_f32 v[60:61], v[96:97], v[50:51] op_sel:[0,0] op_sel_hi:[1,0]
    v_pk_mul_f32 v[62:63], v[98:99], v[50:51] op_sel:[0,0] op_sel_hi:[1,0]
    s_waitcnt lgkmcnt(4)
    v_pk_add_f32 v[104:105], v[104:105], v[108:109]
    v_pk_add_f32 v[106:107], v[106:107], v[110:111]
    v_fmac_f32 v59, v52, v53
    v_pk_fma_f32 v[60:61], v[104:105], v[52:53], v[60:61] op_sel:[0,0,0] op_sel_hi:[1,0,1]
    v_pk_fma_f32 v[62:63], v[106:107], v[52:53], v[62:63] op_sel:[0,0,0] op_sel_hi:[1,0,1]
    s_waitcnt lgkmcnt(2)
    v_pk_add_f32 v[112:113], v[112:113], v[116:117]
    v_pk_add_f32 v[114:115], v[114:115], v[118:119]
    v_fmac_f32 v59, v54, v55
    v_pk_fma_f32 v[60:61], v[112:113], v[54:55], v[60:61] op_sel:[0,0,0] op_sel_hi:[1,0,1]
    v_pk_fma_f32 v[62:63], v[114:115], v[54:55], v[62:63] op_sel:[0,0,0] op_sel_hi:[1,0,1]
L_hop_comb_3:
    s_cbranch_execz L_hop_comb_4
    s_waitcnt lgkmcnt(0)
    v_pk_add_f32 v[120:121], v[120:121], v[124:125]
    v_pk_add_f32 v[122:123], v[122:123], v[126:127]
    v_fmac_f32 v59, v56, v57
    v_pk_fma_f32 v[60:61], v[120:121], v[56:57], v[60:61] op_sel:[0,0,0] op_sel_hi:[1,0,1]
    v_pk_fma_f32 v[62:63], v[122:123], v[56:57], v[62:63] op_sel:[0,0,0] op_sel_hi:[1,0,1]
    v_cndmask_b32 v60, v60, v58, vcc
    v_cndmask_b32 v61, v61, v59, vcc
    v_bfi_b32 v60, v8, s64, v60
    v_bfi_b32 v61, v8, s65, v61
    v_bfi_b32 v62, v8, s66, v62
    v_bfi_b32 v63, v8, s67, v63
    s_mov_b32 exec_lo, 0xffffffff
    s_mov_b32 exec_hi, 0x1ffff
    buffer_store_dwordx4 v[60:63], v44, s[52:55], s76 offen sc1
    s_mov_b64 exec, -1
L_opub:
    s_cmp_eq_u32 s70, 1
    s_cbranch_scc1 L_roleW
    s_cmp_eq_u32 s70, 2
    s_cbranch_scc1 L_roleF
    s_cmp_eq_u32 s70, 3
    s_cbranch_scc1 L_roleR
    s_branch L_fin
L_hop_comb_4:
    s_cbranch_execz L_hopret_comb
L_roleW:
    s_cmp_lg_u32 s3, 1
    s_cbranch_scc1 L_wnt
    s_mov_b64 exec, 0
    s_branch L_hop_W_0
L_hopret_W:
    s_mov_b64 exec, -1
L_wnt:
    v_min_u32 v44, 47, v0
    v_lshlrev_b32 v44, 4, v44
    v_lshlrev_b32 v50, 4, v0
    s_mul_i32 s76, s3, 192
    v_mul_u32_u24 v48, 24, v1
    v_add_u32 v48, s76, v48
    v_mov_b32 v46, 0
    ds_read_b64 v[96:97], v48 offset:13312
    ds_read_b64 v[98:99], v48 offset:13320
    ds_read_b64 v[100:101], v48 offset:13328
    ds_read_b64 v[102:103], v48 offset:14080
    ds_read_b64 v[104:105], v48 offset:14088
    ds_read_b64 v[106:107], v48 offset:14096
    ds_read_b64 v[52:53], v46 offset:14848
    ds_read_b128 v[56:59], v44 offset:14912
    v_and_b32 v49, 1, v0
    v_bfe_u32 v47, v0, 1, 3
    v_lshlrev_b32 v47, 4, v47
    v_lshl_add_u32 v49, v49, 8, v47
    s_mul_i32 s76, s3, 768
    v_add_u32 v51, s76, v44
    s_lshl_b32 s76, s3, 10
    v_add_u32 v55, s76, v50
    s_waitcnt lgkmcnt(0)
    s_cmp_eq_u32 s3, 3
    s_cbranch_scc1 L_wo1
    v_mov_b32 v56, 0
    v_mov_b32 v57, 0
    v_mov_b32 v58, 0
    v_mov_b32 v59, 0
L_wo1:
    v_and_b32 v36, v4, v96
    v_and_b32 v37, v5, v96
    v_and_b32 v38, v6, v96
    v_and_b32 v39, v7, v96
    v_and_b32 v40, v4, v97
    v_and_b32 v41, v5, v97
    v_and_b32 v42, v6, v97
    v_and_b32 v43, v7, v97
    v_mfma_f32_16x16x32_bf16 v[24:27], v[36:39], a[144:147], 0
    v_and_b32 v36, v4, v98
    v_and_b32 v37, v5, v98
    v_and_b32 v38, v6, v98
    v_and_b32 v39, v7, v98
    v_mfma_f32_16x16x32_bf16 v[24:27], v[40:43], a[148:151], v[24:27]
    v_and_b32 v40, v4, v99
    v_and_b32 v41, v5, v99
    v_and_b32 v42, v6, v99
    v_and_b32 v43, v7, v99
    v_mfma_f32_16x16x32_bf16 v[24:27], v[36:39], a[152:155], v[24:27]
    v_and_b32 v36, v4, v100
    v_and_b32 v37, v5, v100
    v_and_b32 v38, v6, v100
    v_and_b32 v39, v7, v100
    v_mfma_f32_16x16x32_bf16 v[24:27], v[40:43], a[156:159], v[24:27]
    v_and_b32 v40, v4, v101
    v_and_b32 v41, v5, v101
    v_and_b32 v42, v6, v101
    v_and_b32 v43, v7, v101
    v_mfma_f32_16x16x32_bf16 v[24:27], v[36:39], a[160:163], v[24:27]
    v_and_b32 v36, v4, v102
    v_and_b32 v37, v5, v102
    v_and_b32 v38, v6, v102
    v_and_b32 v39, v7, v102
    v_mfma_f32_16x16x32_bf16 v[24:27], v[40:43], a[164:167], v[24:27]
    v_and_b32 v40, v4, v103
    v_and_b32 v41, v5, v103
    v_and_b32 v42, v6, v103
    v_and_b32 v43, v7, v103
    v_mfma_f32_16x16x32_bf16 v[24:27], v[36:39], a[168:171], v[24:27]
    v_and_b32 v36, v4, v104
    v_and_b32 v37, v5, v104
    v_and_b32 v38, v6, v104
    v_and_b32 v39, v7, v104
    v_mfma_f32_16x16x32_bf16 v[24:27], v[40:43], a[172:175], v[24:27]
    v_and_b32 v40, v4, v105
    v_and_b32 v41, v5, v105
    v_and_b32 v42, v6, v105
    v_and_b32 v43, v7, v105
    v_mfma_f32_16x16x32_bf16 v[24:27], v[36:39], a[176:179], v[24:27]
    v_and_b32 v36, v4, v106
    v_and_b32 v37, v5, v106
    v_and_b32 v38, v6, v106
    v_and_b32 v39, v7, v106
    v_mfma_f32_16x16x32_bf16 v[24:27], v[40:43], a[180:183], v[24:27]
    v_and_b32 v40, v4, v107
    v_and_b32 v41, v5, v107
    v_and_b32 v42, v6, v107
    v_and_b32 v43, v7, v107
    v_mfma_f32_16x16x32_bf16 v[24:27], v[36:39], a[184:187], v[24:27]
    s_nop 0
    v_mfma_f32_16x16x32_bf16 v[24:27], v[40:43], a[188:191], v[24:27]
    s_cmp_eq_u32 s88, 0
    s_cselect_b32 s77, 16, 24
    s_cselect_b32 s78, 4, 6
    s_mul_i32 s9, s78, s3
    s_add_u32 s78, s78, s9
    s_sub_u32 s78, s78, 1
    s_mul_i32 s76, s88, 24576
    s_add_u32 s76, s76, 2097152
    s_add_u32 s79, s9, 0
    s_cmp_gt_u32 s79, s78
    s_cselect_b32 s79, 31, s79
    s_mov_b32 s22, s79
    s_add_u32 s79, s9, 1
    s_cmp_gt_u32 s79, s78
    s_cselect_b32 s79, 31, s79
    s_mov_b32 s23, s79
    s_add_u32 s79, s9, 2
    s_cmp_gt_u32 s79, s78
    s_cselect_b32 s79, 31, s79
    s_mov_b32 s24, s79
    s_add_u32 s79, s9, 3
    s_cmp_gt_u32 s79, s78
    s_cselect_b32 s79, 31, s79
    s_mov_b32 s25, s79
    s_add_u32 s79, s9, 4
    s_cmp_gt_u32 s79, s78
    s_cselect_b32 s79, 31, s79
    s_mov_b32 s26, s79
    s_add_u32 s79, s9, 5
    s_cmp_gt_u32 s79, s78
    s_cselect_b32 s79, 31, s79
    s_mov_b32 s27, s79
    s_mul_i32 s80, s88, 2560
    s_lshl_b32 s79, s89, 8
    s_add_u32 s80, s80, s79
    s_add_u32 s80, s80, 655360
L_hop_W_0:
    s_cbranch_execz L_hop_W_1
    v_mov_b32 v46, s77
    v_subrev_u32 v46, 1, v46
    v_and_b32 v45, 31, v0
    v_cmp_gt_u32 s[90:91], s77, v45
    v_min_u32 v45, v46, v45
    v_lshlrev_b32 v45, 10, v45
    s_add_u32 s79, s9, 0
    s_min_u32 s16, s79, s78
    s_lshl_b32 s16, s16, 10
    s_add_u32 s16, s16, s76
    s_add_u32 s79, s9, 1
    s_min_u32 s17, s79, s78
    s_lshl_b32 s17, s17, 10
    s_add_u32 s17, s17, s76
    s_add_u32 s79, s9, 2
    s_min_u32 s18, s79, s78
    s_lshl_b32 s18, s18, 10
    s_add_u32 s18, s18, s76
    s_add_u32 s79, s9, 3
    s_min_u32 s19, s79, s78
    s_lshl_b32 s19, s19, 10
    s_add_u32 s19, s19, s76
    s_add_u32 s79, s9, 4
    s_min_u32 s20, s79, s78
    s_lshl_b32 s20, s20, 10
    s_add_u32 s20, s20, s76
    s_add_u32 s79, s9, 5
    s_min_u32 s21, s79, s78
    s_lshl_b32 s21, s21, 10
    s_add_u32 s21, s21, s76
    s_mov_b32 s75, 0
L_poll13:
    buffer_load_dwordx4 v[144:147], v45, s[52:55], s76 offen offset:768 sc1
    buffer_load_dwordx4 v[96:99], v44, s[52:55], s16 offen sc1
    buffer_load_dwordx4 v[100:103], v44, s[52:55], s17 offen sc1
    buffer_load_dwordx4 v[104:107], v44, s[52:55], s18 offen sc1
    buffer_load_dwordx4 v[108:111], v44, s[52:55], s19 offen sc1
    buffer_load_dwordx4 v[112:115], v44, s[52:55], s20 offen sc1
    buffer_load_dwordx4 v[116:119], v44, s[52:55], s21 offen sc1
    s_add_u32 s75, s75, 1
    s_cmp_gt_u32 s75, 2097152
    s_cbranch_scc1 L_done
    s_waitcnt vmcnt(6)
    v_xor_b32 v144, s64, v144
    v_xor_b32 v145, s65, v145
    v_xor_b32 v146, s66, v146
    v_xor_b32 v147, s67, v147
    v_or3_b32 v46, v144, v145, v146
    v_or_b32 v46, v46, v147
    s_waitcnt vmcnt(5)
L_hop_W_1:
    s_cbranch_execz L_hop_W_2
    v_xor_b32 v96, s64, v96
    v_xor_b32 v97, s65, v97
    v_xor_b32 v98, s66, v98
    v_xor_b32 v99, s67, v99
    v_or3_b32 v46, v96, v97, v46
    v_or3_b32 v46, v98, v99, v46
    s_waitcnt vmcnt(4)
    v_xor_b32 v100, s64, v100
    v_xor_b32 v101, s65, v101
    v_xor_b32 v102, s66, v102
    v_xor_b32 v103, s67, v103
    v_or3_b32 v46, v100, v101, v46
    v_or3_b32 v46, v102, v103, v46
    s_waitcnt vmcnt(3)
    v_xor_b32 v104, s64, v104
    v_xor_b32 v105, s65, v105
    v_xor_b32 v106, s66, v106
    v_xor_b32 v107, s67, v107
    v_or3_b32 v46, v104, v105, v46
    v_or3_b32 v46, v106, v107, v46
    s_waitcnt vmcnt(2)
    v_xor_b32 v108, s64, v108
    v_xor_b32 v109, s65, v109
    v_xor_b32 v110, s66, v110
    v_xor_b32 v111, s67, v111
    v_or3_b32 v46, v108, v109, v46
    v_or3_b32 v46, v110, v111, v46
    s_waitcnt vmcnt(1)
    v_xor_b32 v112, s64, v112
    v_xor_b32 v113, s65, v113
    v_xor_b32 v114, s66, v114
    v_xor_b32 v115, s67, v115
    v_or3_b32 v46, v112, v113, v46
    v_or3_b32 v46, v114, v115, v46
    s_waitcnt vmcnt(0)
    v_xor_b32 v116, s64, v116
    v_xor_b32 v117, s65, v117
    v_xor_b32 v118, s66, v118
    v_xor_b32 v119, s67, v119
    v_or3_b32 v46, v116, v117, v46
    v_or3_b32 v46, v118, v119, v46
    v_and_b32 v46, v8, v46
    v_cmp_ne_u32 vcc, 0, v46
    s_cbranch_vccnz L_poll13
    v_mul_f32 v144, v9, v144
    v_mov_b32 v46, 0xff800000
    v_cndmask_b32 v144, v46, v144, s[90:91]
    v_mov_b32 v54, v144
    s_nop 1
L_hop_W_2:
    s_cbranch_execz L_hop_W_3
    v_max_f32_dpp v54, v54, v54 quad_perm:[1,0,3,2] row_mask:0xf bank_mask:0xf
    s_nop 1
    v_max_f32_dpp v54, v54, v54 quad_perm:[2,3,0,1] row_mask:0xf bank_mask:0xf
    s_nop 1
    v_max_f32_dpp v54, v54, v54 row_half_mirror row_mask:0xf bank_mask:0xf
    s_nop 1
    v_max_f32_dpp v54, v54, v54 row_ror:8 row_mask:0xf bank_mask:0xf
    v_mov_b32 v46, v54
    s_nop 1
    v_permlane16_swap_b32 v54, v46
    v_max_f32 v54, v54, v46
    v_max_f32 v54, v54, v52
    v_sub_f32 v144, v144, v54
    v_sub_f32 v52, v52, v54
    v_exp_f32 v144, v144
    v_exp_f32 v52, v52
    v_mul_f32 v145, v145, v144
    v_readlane_b32 s16, v144, s22
    v_readlane_b32 s17, v144, s23
    v_readlane_b32 s18, v144, s24
    v_readlane_b32 s19, v144, s25
    v_readlane_b32 s20, v144, s26
    v_readlane_b32 s21, v144, s27
    v_add_f32_dpp v145, v145, v145 quad_perm:[1,0,3,2] row_mask:0xf bank_mask:0xf
    v_pk_mul_f32 v[60:61], v[56:57], v[52:53] op_sel:[0,0] op_sel_hi:[1,0]
    v_pk_mul_f32 v[62:63], v[58:59], v[52:53] op_sel:[0,0] op_sel_hi:[1,0]
    v_add_f32_dpp v145, v145, v145 quad_perm:[2,3,0,1] row_mask:0xf bank_mask:0xf
    v_pk_fma_f32 v[60:61], v[96:97], s[16:17], v[60:61] op_sel:[0,0,0] op_sel_hi:[1,0,1]
    v_pk_fma_f32 v[62:63], v[98:99], s[16:17], v[62:63] op_sel:[0,0,0] op_sel_hi:[1,0,1]
    v_add_f32_dpp v145, v145, v145 row_half_mirror row_mask:0xf bank_mask:0xf
    v_pk_fma_f32 v[60:61], v[100:101], s[16:17], v[60:61] op_sel:[0,1,0] op_sel_hi:[1,1,1]
    v_pk_fma_f32 v[62:63], v[102:103], s[16:17], v[62:63] op_sel:[0,1,0] op_sel_hi:[1,1,1]
    v_add_f32_dpp v145, v145, v145 row_ror:8 row_mask:0xf bank_mask:0xf
    v_pk_fma_f32 v[60:61], v[104:105], s[18:19], v[60:61] op_sel:[0,0,0] op_sel_hi:[1,0,1]
    v_pk_fma_f32 v[62:63], v[106:107], s[18:19], v[62:63] op_sel:[0,0,0] op_sel_hi:[1,0,1]
    v_mov_b32 v46, v145
    v_pk_fma_f32 v[60:61], v[108:109], s[18:19], v[60:61] op_sel:[0,1,0] op_sel_hi:[1,1,1]
    v_pk_fma_f32 v[62:63], v[110:111], s[18:19], v[62:63] op_sel:[0,1,0] op_sel_hi:[1,1,1]
    v_permlane16_swap_b32 v145, v46
L_hop_W_3:
    s_cbranch_execz L_hop_W_4
    v_pk_fma_f32 v[60:61], v[112:113], s[20:21], v[60:61] op_sel:[0,0,0] op_sel_hi:[1,0,1]
    v_pk_fma_f32 v[62:63], v[114:115], s[20:21], v[62:63] op_sel:[0,0,0] op_sel_hi:[1,0,1]
    v_add_f32 v145, v145, v46
    v_pk_fma_f32 v[60:61], v[116:117], s[20:21], v[60:61] op_sel:[0,1,0] op_sel_hi:[1,1,1]
    v_pk_fma_f32 v[62:63], v[118:119], s[20:21], v[62:63] op_sel:[0,1,0] op_sel_hi:[1,1,1]
    v_fmac_f32 v145, v53, v52
    v_rcp_f32 v145, v145
    s_nop 0
    v_pk_mul_f32 v[60:61], v[60:61], v[144:145] op_sel:[0,1] op_sel_hi:[1,1]
    v_pk_mul_f32 v[62:63], v[62:63], v[144:145] op_sel:[0,1] op_sel_hi:[1,1]
    ds_write_b128 v51, v[60:63] offset:28672
    s_waitcnt lgkmcnt(0)
    s_barrier
    ds_read_b64 v[104:105], v48 offset:28672
    ds_read_b64 v[106:107], v48 offset:29440
    ds_read_b64 v[108:109], v48 offset:30208
    ds_read_b64 v[110:111], v48 offset:30976
    ds_read_b64 v[112:113], v48 offset:28680
    ds_read_b64 v[114:115], v48 offset:29448
    ds_read_b64 v[116:117], v48 offset:30216
    ds_read_b64 v[118:119], v48 offset:30984
    ds_read_b64 v[120:121], v48 offset:28688
    ds_read_b64 v[122:123], v48 offset:29456
    ds_read_b64 v[124:125], v48 offset:30224
    ds_read_b64 v[126:127], v48 offset:30992
    s_waitcnt lgkmcnt(8)
    v_pk_add_f32 v[104:105], v[104:105], v[106:107]
    v_pk_add_f32 v[108:109], v[108:109], v[110:111]
    v_pk_add_f32 v[104:105], v[104:105], v[108:109]
    v_cvt_pk_bf16_f32 v96, v104, v104
    v_cvt_pk_bf16_f32 v97, v105, v105
    s_waitcnt lgkmcnt(4)
    v_pk_add_f32 v[112:113], v[112:113], v[114:115]
    v_pk_add_f32 v[116:117], v[116:117], v[118:119]
    v_pk_add_f32 v[112:113], v[112:113], v[116:117]
    v_cvt_pk_bf16_f32 v98, v112, v112
L_hop_W_4:
    s_cbranch_execz L_hop_W_5
    v_cvt_pk_bf16_f32 v99, v113, v113
    s_waitcnt lgkmcnt(0)
    v_pk_add_f32 v[120:121], v[120:121], v[122:123]
    v_pk_add_f32 v[124:125], v[124:125], v[126:127]
    v_pk_add_f32 v[120:121], v[120:121], v[124:125]
    v_cvt_pk_bf16_f32 v100, v120, v120
    v_cvt_pk_bf16_f32 v101, v121, v121
    v_and_b32 v36, v4, v96
    v_and_b32 v37, v5, v96
    v_and_b32 v38, v6, v96
    v_and_b32 v39, v7, v96
    v_and_b32 v40, v4, v97
    v_and_b32 v41, v5, v97
    v_and_b32 v42, v6, v97
    v_and_b32 v43, v7, v97
    v_mfma_f32_16x16x32_bf16 v[24:27], v[36:39], a[192:195], v[24:27]
    v_and_b32 v36, v4, v98
    v_and_b32 v37, v5, v98
    v_and_b32 v38, v6, v98
    v_and_b32 v39, v7, v98
    v_mfma_f32_16x16x32_bf16 v[24:27], v[40:43], a[196:199], v[24:27]
    v_and_b32 v40, v4, v99
    v_and_b32 v41, v5, v99
    v_and_b32 v42, v6, v99
    v_and_b32 v43, v7, v99
    v_mfma_f32_16x16x32_bf16 v[24:27], v[36:39], a[200:203], v[24:27]
    v_and_b32 v36, v4, v100
    v_and_b32 v37, v5, v100
    v_and_b32 v38, v6, v100
    v_and_b32 v39, v7, v100
    v_mfma_f32_16x16x32_bf16 v[24:27], v[40:43], a[204:207], v[24:27]
    v_and_b32 v40, v4, v101
    v_and_b32 v41, v5, v101
    v_and_b32 v42, v6, v101
    v_and_b32 v43, v7, v101
    v_mfma_f32_16x16x32_bf16 v[24:27], v[36:39], a[208:211], v[24:27]
    s_nop 0
    v_mfma_f32_16x16x32_bf16 v[24:27], v[40:43], a[212:215], v[24:27]
    s_nop 7
    ds_write_b128 v55, v[24:27] offset:24576
    s_waitcnt lgkmcnt(0)
    s_barrier
    s_cmp_lg_u32 s3, 0
    s_cbranch_scc1 L_fin
    ds_read_b128 v[96:99], v49 offset:24576
    ds_read_b128 v[100:103], v49 offset:25216
    ds_read_b128 v[104:107], v49 offset:25600
L_hop_W_5:
    s_cbranch_execz L_hop_W_6
    ds_read_b128 v[108:111], v49 offset:26240
    ds_read_b128 v[112:115], v49 offset:26624
    ds_read_b128 v[116:119], v49 offset:27264
    ds_read_b128 v[120:123], v49 offset:27648
    ds_read_b128 v[124:127], v49 offset:28288
    s_waitcnt lgkmcnt(6)
    v_pk_add_f32 v[96:97], v[96:97], v[100:101]
    v_pk_add_f32 v[98:99], v[98:99], v[102:103]
    s_waitcnt lgkmcnt(4)
    v_pk_add_f32 v[104:105], v[104:105], v[108:109]
    v_pk_add_f32 v[106:107], v[106:107], v[110:111]
    s_waitcnt lgkmcnt(2)
    v_pk_add_f32 v[112:113], v[112:113], v[116:117]
    v_pk_add_f32 v[114:115], v[114:115], v[118:119]
    s_waitcnt lgkmcnt(0)
    v_pk_add_f32 v[120:121], v[120:121], v[124:125]
    v_pk_add_f32 v[122:123], v[122:123], v[126:127]
    v_pk_add_f32 v[96:97], v[96:97], v[104:105]
    v_pk_add_f32 v[98:99], v[98:99], v[106:107]
    v_pk_add_f32 v[112:113], v[112:113], v[120:121]
    v_pk_add_f32 v[114:115], v[114:115], v[122:123]
    v_pk_add_f32 v[60:61], v[96:97], v[112:113]
    v_pk_add_f32 v[62:63], v[98:99], v[114:115]
    s_mov_b64 exec, 0xffff
    v_bfi_b32 v60, v8, s64, v60
    v_bfi_b32 v61, v8, s65, v61
    v_bfi_b32 v62, v8, s66, v62
    v_bfi_b32 v63, v8, s67, v63
    buffer_store_dwordx4 v[60:63], v50, s[52:55], s80 offen sc1
    s_mov_b64 exec, -1
    s_branch L_fin
L_hop_W_6:
    s_cbranch_execz L_hopret_W
L_roleF:
    s_cmp_lg_u32 s3, 1
    s_cbranch_scc1 L_fnt
    s_mov_b64 exec, 0
    s_branch L_hop_F_0
L_hopret_F:
    s_mov_b64 exec, -1
L_fnt:
    s_mov_b32 s60, s16
    s_mov_b32 s61, s17
    s_mov_b32 s62, 1280
    s_mov_b32 s63, 0x20000
    s_mul_i32 s80, s3, 640
    s_mul_i32 s76, s3, 320
    v_lshlrev_b32 v44, 4, v0
    v_lshlrev_b32 v45, 3, v0
    buffer_load_dwordx2 v[68:69], v45, s[60:63], s76 offen
    s_add_u32 s16, s80, 9216
    s_add_u32 s17, s80, 14336
    s_add_u32 s18, s80, 24576
    s_add_u32 s19, s80, 29696
    s_add_u32 s20, s80, 39936
    s_add_u32 s21, s80, 45056
    s_add_u32 s22, s80, 55296
    s_add_u32 s23, s80, 60416
    s_mov_b32 exec_lo, 0xffffffff
    s_mov_b32 exec_hi, 0xff
    s_mov_b32 s75, 0
L_poll14:
    buffer_load_dwordx4 v[96:99], v44, s[52:55], s16 offen offset:0 sc1
    buffer_load_dwordx4 v[112:115], v44, s[52:55], s16 offen offset:2560 sc1
    buffer_load_dwordx4 v[128:131], v44, s[52:55], s17 offen offset:0 sc1
    buffer_load_dwordx4 v[100:103], v44, s[52:55], s18 offen offset:0 sc1
    buffer_load_dwordx4 v[116:119], v44, s[52:55], s18 offen offset:2560 sc1
    buffer_load_dwordx4 v[132:135], v44, s[52:55], s19 offen offset:0 sc1
    buffer_load_dwordx4 v[104:107], v44, s[52:55], s20 offen offset:0 sc1
    buffer_load_dwordx4 v[120:123], v44, s[52:55], s20 offen offset:2560 sc1
    buffer_load_dwordx4 v[136:139], v44, s[52:55], s21 offen offset:0 sc1
    buffer_load_dwordx4 v[108:111], v44, s[52:55], s22 offen offset:0 sc1
    buffer_load_dwordx4 v[124:127], v44, s[52:55], s22 offen offset:2560 sc1
    buffer_load_dwordx4 v[140:143], v44, s[52:55], s23 offen offset:0 sc1
    s_add_u32 s75, s75, 1
    s_cmp_gt_u32 s75, 2097152
    s_cbranch_scc1 L_done
    s_waitcnt vmcnt(11)
    v_xor_b32 v96, s64, v96
    v_xor_b32 v97, s65, v97
    v_xor_b32 v98, s66, v98
    v_xor_b32 v99, s67, v99
    v_or3_b32 v46, v96, v97, v98
    v_or_b32 v46, v46, v99
    s_waitcnt vmcnt(10)
    v_xor_b32 v112, s64, v112
    v_xor_b32 v113, s65, v113
    v_xor_b32 v114, s66, v114
    v_xor_b32 v115, s67, v115
    v_or3_b32 v46, v112, v113, v46
    v_or3_b32 v46, v114, v115, v46
    s_waitcnt vmcnt(9)
    v_xor_b32 v128, s64, v128
    v_xor_b32 v129, s65, v129
    v_xor_b32 v130, s66, v130
    v_xor_b32 v131, s67, v131
    v_or3_b32 v46, v128, v129, v46
    v_or3_b32 v46, v130, v131, v46
    s_waitcnt vmcnt(8)
    v_xor_b32 v100, s64, v100
    v_xor_b32 v101, s65, v101
    v_xor_b32 v102, s66, v102
    v_xor_b32 v103, s67, v103
    v_or3_b32 v46, v100, v101, v46
    v_or3_b32 v46, v102, v103, v46
    s_waitcnt vmcnt(7)
    v_xor_b32 v116, s64, v116
    v_xor_b32 v117, s65, v117
    v_xor_b32 v118, s66, v118
    v_xor_b32 v119, s67, v119
    v_or3_b32 v46, v116, v117, v46
    v_or3_b32 v46, v118, v119, v46
    s_waitcnt vmcnt(6)
    v_xor_b32 v132, s64, v132
    v_xor_b32 v133, s65, v133
    v_xor_b32 v134, s66, v134
    v_xor_b32 v135, s67, v135
    v_or3_b32 v46, v132, v133, v46
    v_or3_b32 v46, v134, v135, v46
    s_waitcnt vmcnt(5)
    v_xor_b32 v104, s64, v104
    v_xor_b32 v105, s65, v105
    v_xor_b32 v106, s66, v106
    v_xor_b32 v107, s67, v107
    v_or3_b32 v46, v104, v105, v46
    v_or3_b32 v46, v106, v107, v46
    s_waitcnt vmcnt(4)
    v_xor_b32 v120, s64, v120
    v_xor_b32 v121, s65, v121
    v_xor_b32 v122, s66, v122
    v_xor_b32 v123, s67, v123
    v_or3_b32 v46, v120, v121, v46
    v_or3_b32 v46, v122, v123, v46
    s_waitcnt vmcnt(3)
    v_xor_b32 v136, s64, v136
    v_xor_b32 v137, s65, v137
    v_xor_b32 v138, s66, v138
    v_xor_b32 v139, s67, v139
    v_or3_b32 v46, v136, v137, v46
    v_or3_b32 v46, v138, v139, v46
    s_waitcnt vmcnt(2)
    v_xor_b32 v108, s64, v108
    v_xor_b32 v109, s65, v109
    v_xor_b32 v110, s66, v110
    v_xor_b32 v111, s67, v111
    v_or3_b32 v46, v108, v109, v46
    v_or3_b32 v46, v110, v111, v46
    s_waitcnt vmcnt(1)
    v_xor_b32 v124, s64, v124
    v_xor_b32 v125, s65, v125
    v_xor_b32 v126, s66, v126
    v_xor_b32 v127, s67, v127
    v_or3_b32 v46, v124, v125, v46
    v_or3_b32 v46, v126, v127, v46
    s_waitcnt vmcnt(0)
    v_xor_b32 v140, s64, v140
    v_xor_b32 v141, s65, v141
    v_xor_b32 v142, s66, v142
    v_xor_b32 v143, s67, v143
    v_or3_b32 v46, v140, v141, v46
    v_or3_b32 v46, v142, v143, v46
    v_and_b32 v46, v8, v46
    v_cmp_ne_u32 vcc, 0, v46
    s_cbranch_vccnz L_poll14
    v_pk_add_f32 v[96:97], v[96:97], v[100:101]
    v_pk_add_f32 v[98:99], v[98:99], v[102:103]
    v_pk_add_f32 v[104:105], v[104:105], v[108:109]
    v_pk_add_f32 v[106:107], v[106:107], v[110:111]
    v_pk_add_f32 v[52:53], v[96:97], v[104:105]
    v_pk_add_f32 v[54:55], v[98:99], v[106:107]
    v_cvt_pk_bf16_f32 v46, v52, v53
    v_cvt_pk_bf16_f32 v47, v54, v55
    v_lshlrev_b32 v52, 16, v46
    v_and_b32 v53, 0xffff0000, v46
    v_lshlrev_b32 v54, 16, v47
    v_and_b32 v55, 0xffff0000, v47
    v_pk_add_f32 v[112:113], v[112:113], v[116:117]
    v_pk_add_f32 v[114:115], v[114:115], v[118:119]
    v_pk_add_f32 v[120:121], v[120:121], v[124:125]
    v_pk_add_f32 v[122:123], v[122:123], v[126:127]
    v_pk_add_f32 v[56:57], v[112:113], v[120:121]
    v_pk_add_f32 v[58:59], v[114:115], v[122:123]
    v_cvt_pk_bf16_f32 v46, v56, v57
    v_cvt_pk_bf16_f32 v47, v58, v59
    v_lshlrev_b32 v56, 16, v46
    v_and_b32 v57, 0xffff0000, v46
    v_lshlrev_b32 v58, 16, v47
    v_and_b32 v59, 0xffff0000, v47
    v_pk_add_f32 v[128:129], v[128:129], v[132:133]
    v_pk_add_f32 v[130:131], v[130:131], v[134:135]
    v_pk_add_f32 v[136:137], v[136:137], v[140:141]
    v_pk_add_f32 v[138:139], v[138:139], v[142:143]
    v_pk_add_f32 v[60:61], v[128:129], v[136:137]
    v_pk_add_f32 v[62:63], v[130:131], v[138:139]
    v_cvt_pk_bf16_f32 v46, v60, v61
    v_cvt_pk_bf16_f32 v47, v62, v63
    v_lshlrev_b32 v60, 16, v46
    v_and_b32 v61, 0xffff0000, v46
    v_lshlrev_b32 v62, 16, v47
    v_and_b32 v63, 0xffff0000, v47
    v_lshlrev_b32 v64, 16, v68
    v_and_b32 v65, 0xffff0000, v68
    v_lshlrev_b32 v66, 16, v69
    v_and_b32 v67, 0xffff0000, v69
    v_add_f32 v60, 1.0, v60
    v_add_f32 v61, 1.0, v61
    v_add_f32 v62, 1.0, v62
    v_add_f32 v63, 1.0, v63
    v_cvt_pk_bf16_f32 v46, v60, v61
    v_cvt_pk_bf16_f32 v47, v62, v63
    v_lshlrev_b32 v60, 16, v46
    v_and_b32 v61, 0xffff0000, v46
    v_lshlrev_b32 v62, 16, v47
    v_and_b32 v63, 0xffff0000, v47
    v_add_u32 v72, s80, v45
    v_cvt_pk_bf16_f32 v68, v60, v61
    v_cvt_pk_bf16_f32 v69, v62, v63
    v_cvt_pk_bf16_f32 v70, v56, v57
    v_cvt_pk_bf16_f32 v71, v58, v59
    ds_write_b64 v72, v[68:69] offset:16384
    ds_write_b64 v72, v[70:71] offset:16704
    s_mov_b64 exec, -1
    v_lshrrev_b32 v46, 4, v0
    v_lshl_add_u32 v73, v46, 4, s80
    v_bfe_u32 v47, v0, 3, 1
    v_mul_u32_u24 v47, 320, v47
    v_add_u32 v47, v47, v73
    v_and_b32 v75, 1, v0
    v_lshl_add_u32 v75, v46, 1, v75
    v_lshlrev_b32 v75, 4, v75
    v_lshlrev_b32 v76, 2, v0
    s_lshl_b32 s76, s3, 8
    v_add_u32 v74, s76, v76
    s_lshl_b32 s76, s3, 4
    v_mov_b32 v77, s76
    v_mov_b32 v78, 0
    v_mov_b32 v79, 0xc0135761
    v_mov_b32 v80, 0xbdd2d3e8
    s_mul_i32 s9, s88, 2560
    s_lshl_b32 s77, s3, 8
    s_add_u32 s9, s9, s77
    s_add_u32 s9, s9, 720896
    s_mov_b32 s84, 0xffff0000
    s_mov_b32 s85, 0
    s_mov_b32 s86, 0
    s_mov_b32 s87, 0xffff
    s_mov_b32 s82, 0
    s_mov_b32 s83, 0xffff0000
    s_waitcnt lgkmcnt(0)
    ds_read_b128 v[96:99], v47 offset:16384
    ds_read_b128 v[100:103], v47 offset:16448
    ds_read_b128 v[104:107], v47 offset:16512
    ds_read_b128 v[108:111], v47 offset:16576
    ds_read_b128 v[112:115], v47 offset:16640
    v_lshrrev_b32 v46, 5, v0
    v_and_b32 v47, 15, v0
    v_lshlrev_b32 v47, 2, v47
    v_lshl_add_u32 v47, v46, 8, v47
    s_lshl_b32 s76, s3, 9
    v_add_u32 v47, s76, v47
    s_waitcnt lgkmcnt(0)
    v_mfma_f32_16x16x32_bf16 v[184:187], v[96:99], a[144:147], 0
    v_mfma_f32_16x16x32_bf16 v[188:191], v[96:99], a[148:151], 0
    v_mfma_f32_16x16x32_bf16 v[192:195], v[96:99], a[152:155], 0
    v_mfma_f32_16x16x32_bf16 v[196:199], v[96:99], a[156:159], 0
    v_mfma_f32_16x16x32_bf16 v[184:187], v[100:103], a[160:163], v[184:187]
    v_mfma_f32_16x16x32_bf16 v[188:191], v[100:103], a[164:167], v[188:191]
    v_mfma_f32_16x16x32_bf16 v[192:195], v[100:103], a[168:171], v[192:195]
    v_mfma_f32_16x16x32_bf16 v[196:199], v[100:103], a[172:175], v[196:199]
    v_mfma_f32_16x16x32_bf16 v[184:187], v[104:107], a[176:179], v[184:187]
    v_mfma_f32_16x16x32_bf16 v[188:191], v[104:107], a[180:183], v[188:191]
    v_mfma_f32_16x16x32_bf16 v[192:195], v[104:107], a[184:187], v[192:195]
    v_mfma_f32_16x16x32_bf16 v[196:199], v[104:107], a[188:191], v[196:199]
    v_mfma_f32_16x16x32_bf16 v[184:187], v[108:111], a[192:195], v[184:187]
    v_mfma_f32_16x16x32_bf16 v[188:191], v[108:111], a[196:199], v[188:191]
    v_mfma_f32_16x16x32_bf16 v[192:195], v[108:111], a[200:203], v[192:195]
    v_mfma_f32_16x16x32_bf16 v[196:199], v[108:111], a[204:207], v[196:199]
    v_mfma_f32_16x16x32_bf16 v[184:187], v[112:115], a[208:211], v[184:187]
    v_mfma_f32_16x16x32_bf16 v[188:191], v[112:115], a[212:215], v[188:191]
    v_mfma_f32_16x16x32_bf16 v[192:195], v[112:115], a[216:219], v[192:195]
    v_mfma_f32_16x16x32_bf16 v[196:199], v[112:115], a[220:223], v[196:199]
    s_nop 4
    ds_write_b32 v47, v184 offset:28672
    ds_write_b32 v47, v188 offset:28736
    ds_write_b32 v47, v192 offset:28800
    ds_write_b32 v47, v196 offset:28864
    s_waitcnt lgkmcnt(0)
    s_barrier
    ds_read_b128 v[144:147], v75 offset:28672
    ds_read_b128 v[96:99], v75 offset:28928
    ds_read_b128 v[148:151], v75 offset:28800
    ds_read_b128 v[100:103], v75 offset:29056
    ds_read_b128 v[152:155], v75 offset:29184
    ds_read_b128 v[104:107], v75 offset:29440
    ds_read_b128 v[156:159], v75 offset:29312
    ds_read_b128 v[108:111], v75 offset:29568
    ds_read_b128 v[160:163], v75 offset:29696
    ds_read_b128 v[112:115], v75 offset:29952
    ds_read_b128 v[164:167], v75 offset:29824
    ds_read_b128 v[116:119], v75 offset:30080
    ds_read_b128 v[168:171], v75 offset:30208
    ds_read_b128 v[120:123], v75 offset:30464
    ds_read_b128 v[172:175], v75 offset:30336
    ds_read_b128 v[124:127], v75 offset:30592
    v_mov_b32 v48, 0
    v_mov_b32 v49, 0
    s_waitcnt lgkmcnt(0)
    v_pk_add_f32 v[96:97], v[96:97], v[104:105]
    v_pk_add_f32 v[98:99], v[98:99], v[106:107]
    v_pk_add_f32 v[112:113], v[112:113], v[120:121]
    v_pk_add_f32 v[114:115], v[114:115], v[122:123]
    v_pk_add_f32 v[176:177], v[96:97], v[112:113]
    v_pk_add_f32 v[178:179], v[98:99], v[114:115]
    v_pk_add_f32 v[100:101], v[100:101], v[108:109]
    v_pk_add_f32 v[102:103], v[102:103], v[110:111]
    v_pk_add_f32 v[116:117], v[116:117], v[124:125]
    v_pk_add_f32 v[118:119], v[118:119], v[126:127]
    v_pk_add_f32 v[180:181], v[100:101], v[116:117]
    v_pk_add_f32 v[182:183], v[102:103], v[118:119]
L_hop_F_0:
    s_cbranch_execz L_hop_F_1
    s_add_u32 s16, s80, 655360
    s_add_u32 s17, s80, 660480
    s_add_u32 s18, s80, 665600
    s_add_u32 s19, s80, 670720
    s_add_u32 s20, s80, 675840
L_hop_F_1:
    s_cbranch_execz L_hop_F_2
    s_add_u32 s21, s80, 680960
    s_mov_b32 exec_lo, 0xffffffff
    s_mov_b32 exec_hi, 0xff
    s_mov_b32 s75, 0
L_poll15:
    buffer_load_dwordx4 v[96:99], v44, s[52:55], s16 offen offset:0 sc1
    buffer_load_dwordx4 v[100:103], v44, s[52:55], s16 offen offset:2560 sc1
    buffer_load_dwordx4 v[104:107], v44, s[52:55], s17 offen offset:0 sc1
    buffer_load_dwordx4 v[108:111], v44, s[52:55], s17 offen offset:2560 sc1
    buffer_load_dwordx4 v[112:115], v44, s[52:55], s18 offen offset:0 sc1
    buffer_load_dwordx4 v[116:119], v44, s[52:55], s18 offen offset:2560 sc1
    buffer_load_dwordx4 v[120:123], v44, s[52:55], s19 offen offset:0 sc1
    buffer_load_dwordx4 v[124:127], v44, s[52:55], s19 offen offset:2560 sc1
    buffer_load_dwordx4 v[128:131], v44, s[52:55], s20 offen offset:0 sc1
    buffer_load_dwordx4 v[132:135], v44, s[52:55], s20 offen offset:2560 sc1
    buffer_load_dwordx4 v[136:139], v44, s[52:55], s21 offen offset:0 sc1
    s_add_u32 s75, s75, 1
    s_cmp_gt_u32 s75, 2097152
    s_cbranch_scc1 L_done
    s_waitcnt vmcnt(10)
    v_xor_b32 v96, s64, v96
    v_xor_b32 v97, s65, v97
    v_xor_b32 v98, s66, v98
    v_xor_b32 v99, s67, v99
    v_or3_b32 v46, v96, v97, v98
    v_or_b32 v46, v46, v99
    s_waitcnt vmcnt(9)
    v_xor_b32 v100, s64, v100
    v_xor_b32 v101, s65, v101
    v_xor_b32 v102, s66, v102
    v_xor_b32 v103, s67, v103
    v_or3_b32 v46, v100, v101, v46
    v_or3_b32 v46, v102, v103, v46
    s_waitcnt vmcnt(8)
    v_xor_b32 v104, s64, v104
    v_xor_b32 v105, s65, v105
    v_xor_b32 v106, s66, v106
    v_xor_b32 v107, s67, v107
    v_or3_b32 v46, v104, v105, v46
    v_or3_b32 v46, v106, v107, v46
    s_waitcnt vmcnt(7)
    v_xor_b32 v108, s64, v108
    v_xor_b32 v109, s65, v109
    v_xor_b32 v110, s66, v110
L_hop_F_2:
    s_cbranch_execz L_hop_F_3
    v_xor_b32 v111, s67, v111
    v_or3_b32 v46, v108, v109, v46
    v_or3_b32 v46, v110, v111, v46
    s_waitcnt vmcnt(6)
    v_xor_b32 v112, s64, v112
    v_xor_b32 v113, s65, v113
    v_xor_b32 v114, s66, v114
    v_xor_b32 v115, s67, v115
    v_or3_b32 v46, v112, v113, v46
    v_or3_b32 v46, v114, v115, v46
    s_waitcnt vmcnt(5)
    v_xor_b32 v116, s64, v116
    v_xor_b32 v117, s65, v117
    v_xor_b32 v118, s66, v118
    v_xor_b32 v119, s67, v119
    v_or3_b32 v46, v116, v117, v46
    v_or3_b32 v46, v118, v119, v46
    s_waitcnt vmcnt(4)
    v_xor_b32 v120, s64, v120
    v_xor_b32 v121, s65, v121
    v_xor_b32 v122, s66, v122
    v_xor_b32 v123, s67, v123
    v_or3_b32 v46, v120, v121, v46
    v_or3_b32 v46, v122, v123, v46
    s_waitcnt vmcnt(3)
    v_xor_b32 v124, s64, v124
    v_xor_b32 v125, s65, v125
    v_xor_b32 v126, s66, v126
    v_xor_b32 v127, s67, v127
    v_or3_b32 v46, v124, v125, v46
    v_or3_b32 v46, v126, v127, v46
    s_waitcnt vmcnt(2)
    v_xor_b32 v128, s64, v128
    v_xor_b32 v129, s65, v129
    v_xor_b32 v130, s66, v130
    v_xor_b32 v131, s67, v131
    v_or3_b32 v46, v128, v129, v46
    v_or3_b32 v46, v130, v131, v46
    s_waitcnt vmcnt(1)
    v_xor_b32 v132, s64, v132
    v_xor_b32 v133, s65, v133
    v_xor_b32 v134, s66, v134
    v_xor_b32 v135, s67, v135
    v_or3_b32 v46, v132, v133, v46
    v_or3_b32 v46, v134, v135, v46
    s_waitcnt vmcnt(0)
    v_xor_b32 v136, s64, v136
    v_xor_b32 v137, s65, v137
    v_xor_b32 v138, s66, v138
L_hop_F_3:
    s_cbranch_execz L_hop_F_4
    v_xor_b32 v139, s67, v139
    v_or3_b32 v46, v136, v137, v46
    v_or3_b32 v46, v138, v139, v46
    v_and_b32 v46, v8, v46
    v_cmp_ne_u32 vcc, 0, v46
    s_cbranch_vccnz L_poll15
    v_pk_add_f32 v[96:97], v[96:97], v[100:101]
    v_pk_add_f32 v[98:99], v[98:99], v[102:103]
    v_pk_add_f32 v[104:105], v[104:105], v[108:109]
    v_pk_add_f32 v[106:107], v[106:107], v[110:111]
    v_pk_add_f32 v[112:113], v[112:113], v[116:117]
    v_pk_add_f32 v[114:115], v[114:115], v[118:119]
    v_pk_add_f32 v[120:121], v[120:121], v[124:125]
    v_pk_add_f32 v[122:123], v[122:123], v[126:127]
    v_pk_add_f32 v[128:129], v[128:129], v[132:133]
    v_pk_add_f32 v[130:131], v[130:131], v[134:135]
    v_pk_add_f32 v[96:97], v[96:97], v[104:105]
    v_pk_add_f32 v[98:99], v[98:99], v[106:107]
    v_pk_add_f32 v[112:113], v[112:113], v[120:121]
    v_pk_add_f32 v[114:115], v[114:115], v[122:123]
    v_pk_add_f32 v[128:129], v[128:129], v[136:137]
    v_pk_add_f32 v[130:131], v[130:131], v[138:139]
    v_pk_add_f32 v[96:97], v[96:97], v[112:113]
    v_pk_add_f32 v[98:99], v[98:99], v[114:115]
    v_pk_add_f32 v[68:69], v[96:97], v[128:129]
    v_pk_add_f32 v[70:71], v[98:99], v[130:131]
    v_cvt_pk_bf16_f32 v46, v68, v69
    v_cvt_pk_bf16_f32 v47, v70, v71
    v_lshlrev_b32 v68, 16, v46
    v_and_b32 v69, 0xffff0000, v46
    v_lshlrev_b32 v70, 16, v47
    v_and_b32 v71, 0xffff0000, v47
    v_pk_mul_f32 v[68:69], v[68:69], v[52:53]
    v_pk_mul_f32 v[70:71], v[70:71], v[54:55]
    v_cvt_pk_bf16_f32 v46, v68, v69
L_hop_F_4:
    s_cbranch_execz L_hop_F_5
    v_cvt_pk_bf16_f32 v47, v70, v71
    v_lshlrev_b32 v68, 16, v46
    v_and_b32 v69, 0xffff0000, v46
    v_lshlrev_b32 v70, 16, v47
    v_and_b32 v71, 0xffff0000, v47
    v_pk_add_f32 v[64:65], v[64:65], v[68:69]
    v_pk_add_f32 v[66:67], v[66:67], v[70:71]
    v_cvt_pk_bf16_f32 v46, v64, v65
    v_cvt_pk_bf16_f32 v47, v66, v67
    v_lshlrev_b32 v64, 16, v46
    v_and_b32 v65, 0xffff0000, v46
    v_lshlrev_b32 v66, 16, v47
    v_and_b32 v67, 0xffff0000, v47
    v_readfirstlane_b32 s16, v64
    s_nop 1
    v_pk_add_f32 v[64:65], v[64:65], s[16:17] op_sel:[0,0] op_sel_hi:[1,0] neg_lo:[0,1] neg_hi:[0,1]
    v_pk_add_f32 v[66:67], v[66:67], s[16:17] op_sel:[0,0] op_sel_hi:[1,0] neg_lo:[0,1] neg_hi:[0,1]
    v_pk_mul_f32 v[68:69], v[64:65], v[60:61]
    v_pk_mul_f32 v[70:71], v[66:67], v[62:63]
    v_cvt_pk_bf16_f32 v68, v68, v69
    v_cvt_pk_bf16_f32 v69, v70, v71
    ds_write_b64 v72, v[68:69] offset:16384
    v_add_f32 v48, v64, v65
    v_mul_f32 v49, v64, v64
    v_add_f32 v50, v66, v67
    v_fmac_f32 v49, v65, v65
    v_add_f32 v48, v48, v50
    v_fmac_f32 v49, v66, v66
    v_fmac_f32 v49, v67, v67
    s_mov_b64 exec, -1
    s_waitcnt lgkmcnt(0)
    ds_read_b128 v[96:99], v73 offset:16384
    ds_read_b128 v[100:103], v73 offset:16448
    ds_read_b128 v[104:107], v73 offset:16512
    ds_read_b128 v[108:111], v73 offset:16576
    ds_read_b128 v[112:115], v73 offset:16640
    v_add_f32_dpp v48, v48, v48 quad_perm:[1,0,3,2] row_mask:0xf bank_mask:0xf
    v_add_f32_dpp v49, v49, v49 quad_perm:[1,0,3,2] row_mask:0xf bank_mask:0xf
    s_nop 0
L_hop_F_5:
    s_cbranch_execz L_hop_F_6
    v_add_f32_dpp v48, v48, v48 quad_perm:[2,3,0,1] row_mask:0xf bank_mask:0xf
    v_add_f32_dpp v49, v49, v49 quad_perm:[2,3,0,1] row_mask:0xf bank_mask:0xf
    s_nop 0
    v_add_f32_dpp v48, v48, v48 row_half_mirror row_mask:0xf bank_mask:0xf
    v_add_f32_dpp v49, v49, v49 row_half_mirror row_mask:0xf bank_mask:0xf
    s_nop 0
    v_add_f32_dpp v48, v48, v48 row_ror:8 row_mask:0xf bank_mask:0xf
    v_add_f32_dpp v49, v49, v49 row_ror:8 row_mask:0xf bank_mask:0xf
    s_waitcnt lgkmcnt(4)
    v_mov_b32 v50, v48
    v_mov_b32 v51, v49
    v_mfma_f32_16x16x32_bf16 v[184:187], v[96:99], a[144:147], 0
    v_permlane16_swap_b32 v48, v50
    v_permlane16_swap_b32 v49, v51
    v_mfma_f32_16x16x32_bf16 v[188:191], v[96:99], a[148:151], 0
    v_add_f32 v48, v48, v50
    v_add_f32 v49, v49, v51
    v_mfma_f32_16x16x32_bf16 v[192:195], v[96:99], a[152:155], 0
    v_mov_b32 v50, v48
    v_mov_b32 v51, v49
    v_mfma_f32_16x16x32_bf16 v[196:199], v[96:99], a[156:159], 0
    s_waitcnt lgkmcnt(3)
    v_permlane32_swap_b32 v48, v50
    v_permlane32_swap_b32 v49, v51
    v_mfma_f32_16x16x32_bf16 v[184:187], v[100:103], a[160:163], v[184:187]
    v_add_f32 v48, v48, v50
    v_add_f32 v49, v49, v51
    v_mfma_f32_16x16x32_bf16 v[188:191], v[100:103], a[164:167], v[188:191]
    v_mul_f32 v50, 0x3bcccccd, v48
    v_fma_f32 v49, -v50, v48, v49
    v_mfma_f32_16x16x32_bf16 v[192:195], v[100:103], a[168:171], v[192:195]
    v_add_f32 v48, s16, v50
    v_mov_b32 v50, s16
    v_mfma_f32_16x16x32_bf16 v[196:199], v[100:103], a[172:175], v[196:199]
    s_mov_b64 exec, 1
    ds_write_b128 v77, v[48:51] offset:19456
    s_mov_b64 exec, -1
    s_waitcnt lgkmcnt(0)
    s_barrier
    ds_read_b128 v[120:123], v78 offset:19456
    ds_read_b128 v[124:127], v78 offset:19472
    ds_read_b128 v[128:131], v78 offset:19488
    ds_read_b128 v[132:135], v78 offset:19504
L_hop_F_6:
    s_cbranch_execz L_hop_F_7
    v_mfma_f32_16x16x32_bf16 v[184:187], v[104:107], a[176:179], v[184:187]
    v_mfma_f32_16x16x32_bf16 v[188:191], v[104:107], a[180:183], v[188:191]
    v_mfma_f32_16x16x32_bf16 v[192:195], v[104:107], a[184:187], v[192:195]
    v_mfma_f32_16x16x32_bf16 v[196:199], v[104:107], a[188:191], v[196:199]
    v_mfma_f32_16x16x32_bf16 v[184:187], v[108:111], a[192:195], v[184:187]
    v_mfma_f32_16x16x32_bf16 v[188:191], v[108:111], a[196:199], v[188:191]
    s_waitcnt lgkmcnt(0)
    v_pk_add_f32 v[48:49], v[120:121], v[124:125]
    v_pk_add_f32 v[50:51], v[128:129], v[132:133]
    v_pk_add_f32 v[48:49], v[48:49], v[50:51]
    v_mfma_f32_16x16x32_bf16 v[192:195], v[108:111], a[200:203], v[192:195]
    v_mul_f32 v48, 0x3e800000, v48
    v_sub_f32 v120, v120, v48
    v_sub_f32 v124, v124, v48
    v_mfma_f32_16x16x32_bf16 v[196:199], v[108:111], a[204:207], v[196:199]
    v_sub_f32 v128, v128, v48
    v_sub_f32 v132, v132, v48
    v_mul_f32 v50, v120, v120
    v_mfma_f32_16x16x32_bf16 v[184:187], v[112:115], a[208:211], v[184:187]
    v_mul_f32 v51, v124, v124
    v_fmac_f32 v50, v128, v128
    v_fmac_f32 v51, v132, v132
    v_mfma_f32_16x16x32_bf16 v[188:191], v[112:115], a[212:215], v[188:191]
    v_add_f32 v50, v50, v51
    v_fmac_f32 v49, 0x43200000, v50
    v_mul_f32 v49, 0x3acccccd, v49
    v_mfma_f32_16x16x32_bf16 v[192:195], v[112:115], a[216:219], v[192:195]
    v_cvt_pk_bf16_f32 v49, v49, v49
    v_lshlrev_b32 v49, 16, v49
    v_cvt_pk_bf16_f32 v48, v48, v48
    v_mfma_f32_16x16x32_bf16 v[196:199], v[112:115], a[220:223], v[196:199]
    v_lshlrev_b32 v48, 16, v48
    v_add_f32 v49, 0x3727c5ac, v49
    v_cvt_pk_bf16_f32 v49, v49, v49
    v_lshlrev_b32 v49, 16, v49
    v_sqrt_f32 v49, v49
    s_nop 0
    v_cvt_pk_bf16_f32 v49, v49, v49
    v_lshlrev_b32 v49, 16, v49
L_hop_F_7:
    s_cbranch_execz L_hop_F_8
    v_rcp_f32 v49, v49
    v_cndmask_b32 v52, v184, v188, s[84:85]
    v_cndmask_b32 v52, v52, v192, s[86:87]
    v_cndmask_b32 v52, v52, v196, s[82:83]
    ds_write_b32 v74, v52 offset:24576
    v_sub_f32 v122, v122, v48
    v_sub_f32 v126, v126, v48
    v_sub_f32 v130, v130, v48
    v_sub_f32 v134, v134, v48
    v_pk_mul_f32 v[136:137], v[144:145], v[122:123] op_sel:[0,0] op_sel_hi:[1,0]
    v_pk_mul_f32 v[138:139], v[146:147], v[122:123] op_sel:[0,0] op_sel_hi:[1,0]
    v_pk_mul_f32 v[140:141], v[148:149], v[122:123] op_sel:[0,0] op_sel_hi:[1,0]
    v_pk_mul_f32 v[142:143], v[150:151], v[122:123] op_sel:[0,0] op_sel_hi:[1,0]
    v_pk_fma_f32 v[136:137], v[152:153], v[126:127], v[136:137] op_sel:[0,0,0] op_sel_hi:[1,0,1]
    v_pk_fma_f32 v[138:139], v[154:155], v[126:127], v[138:139] op_sel:[0,0,0] op_sel_hi:[1,0,1]
    v_pk_fma_f32 v[140:141], v[156:157], v[126:127], v[140:141] op_sel:[0,0,0] op_sel_hi:[1,0,1]
    v_pk_fma_f32 v[142:143], v[158:159], v[126:127], v[142:143] op_sel:[0,0,0] op_sel_hi:[1,0,1]
    v_pk_fma_f32 v[136:137], v[160:161], v[130:131], v[136:137] op_sel:[0,0,0] op_sel_hi:[1,0,1]
    v_pk_fma_f32 v[138:139], v[162:163], v[130:131], v[138:139] op_sel:[0,0,0] op_sel_hi:[1,0,1]
    v_pk_fma_f32 v[140:141], v[164:165], v[130:131], v[140:141] op_sel:[0,0,0] op_sel_hi:[1,0,1]
    v_pk_fma_f32 v[142:143], v[166:167], v[130:131], v[142:143] op_sel:[0,0,0] op_sel_hi:[1,0,1]
    v_pk_fma_f32 v[136:137], v[168:169], v[134:135], v[136:137] op_sel:[0,0,0] op_sel_hi:[1,0,1]
    v_pk_fma_f32 v[138:139], v[170:171], v[134:135], v[138:139] op_sel:[0,0,0] op_sel_hi:[1,0,1]
    v_pk_fma_f32 v[140:141], v[172:173], v[134:135], v[140:141] op_sel:[0,0,0] op_sel_hi:[1,0,1]
    v_pk_fma_f32 v[142:143], v[174:175], v[134:135], v[142:143] op_sel:[0,0,0] op_sel_hi:[1,0,1]
    v_pk_fma_f32 v[176:177], v[136:137], v[48:49], v[176:177] op_sel:[0,1,0] op_sel_hi:[1,1,1]
    v_pk_fma_f32 v[178:179], v[138:139], v[48:49], v[178:179] op_sel:[0,1,0] op_sel_hi:[1,1,1]
    v_pk_fma_f32 v[180:181], v[140:141], v[48:49], v[180:181] op_sel:[0,1,0] op_sel_hi:[1,1,1]
    v_pk_fma_f32 v[182:183], v[142:143], v[48:49], v[182:183] op_sel:[0,1,0] op_sel_hi:[1,1,1]
    s_waitcnt lgkmcnt(0)
    s_barrier
    ds_read_b128 v[96:99], v75 offset:24576
    ds_read_b128 v[100:103], v75 offset:24832
    ds_read_b128 v[104:107], v75 offset:25088
    ds_read_b128 v[108:111], v75 offset:25344
L_hop_F_8:
    s_cbranch_execz L_hop_F_9
    ds_read_b128 v[112:115], v75 offset:24704
    ds_read_b128 v[116:119], v75 offset:24960
    ds_read_b128 v[120:123], v75 offset:25216
    ds_read_b128 v[124:127], v75 offset:25472
    s_waitcnt lgkmcnt(6)
    v_pk_add_f32 v[96:97], v[96:97], v[100:101]
    v_pk_add_f32 v[98:99], v[98:99], v[102:103]
    s_waitcnt lgkmcnt(4)
    v_pk_add_f32 v[104:105], v[104:105], v[108:109]
    v_pk_add_f32 v[106:107], v[106:107], v[110:111]
    v_pk_add_f32 v[96:97], v[96:97], v[104:105]
    v_pk_add_f32 v[98:99], v[98:99], v[106:107]
    v_pk_fma_f32 v[176:177], v[96:97], v[48:49], v[176:177] op_sel:[0,1,0] op_sel_hi:[1,1,1]
    v_pk_fma_f32 v[178:179], v[98:99], v[48:49], v[178:179] op_sel:[0,1,0] op_sel_hi:[1,1,1]
    v_cvt_pk_bf16_f32 v46, v176, v177
    v_cvt_pk_bf16_f32 v47, v178, v179
    v_lshlrev_b32 v176, 16, v46
    v_and_b32 v177, 0xffff0000, v46
    v_lshlrev_b32 v178, 16, v47
    v_and_b32 v179, 0xffff0000, v47
    v_pk_mul_f32 v[60:61], v[176:177], v[176:177]
    v_pk_mul_f32 v[62:63], v[178:179], v[178:179]
    v_fma_f32 v60, v60, v80, v79
    v_fma_f32 v61, v61, v80, v79
    v_fma_f32 v62, v62, v80, v79
    v_fma_f32 v63, v63, v80, v79
    v_pk_mul_f32 v[60:61], v[60:61], v[176:177]
    v_pk_mul_f32 v[62:63], v[62:63], v[178:179]
    v_exp_f32 v60, v60
    v_exp_f32 v61, v61
    v_exp_f32 v62, v62
    v_exp_f32 v63, v63
    s_waitcnt lgkmcnt(0)
    v_pk_add_f32 v[112:113], v[112:113], v[116:117]
    v_pk_add_f32 v[114:115], v[114:115], v[118:119]
    v_pk_add_f32 v[120:121], v[120:121], v[124:125]
L_hop_F_9:
    s_cbranch_execz L_hop_F_10
    v_pk_add_f32 v[122:123], v[122:123], v[126:127]
    v_pk_add_f32 v[112:113], v[112:113], v[120:121]
    v_pk_add_f32 v[114:115], v[114:115], v[122:123]
    v_pk_fma_f32 v[180:181], v[112:113], v[48:49], v[180:181] op_sel:[0,1,0] op_sel_hi:[1,1,1]
    v_pk_fma_f32 v[182:183], v[114:115], v[48:49], v[182:183] op_sel:[0,1,0] op_sel_hi:[1,1,1]
    v_cvt_pk_bf16_f32 v46, v180, v181
    v_cvt_pk_bf16_f32 v47, v182, v183
    v_lshlrev_b32 v180, 16, v46
    v_and_b32 v181, 0xffff0000, v46
    v_lshlrev_b32 v182, 16, v47
    v_and_b32 v183, 0xffff0000, v47
    v_add_f32 v60, 1.0, v60
    v_add_f32 v61, 1.0, v61
    v_add_f32 v62, 1.0, v62
    v_add_f32 v63, 1.0, v63
    v_rcp_f32 v60, v60
    v_rcp_f32 v61, v61
    v_rcp_f32 v62, v62
    v_rcp_f32 v63, v63
    v_pk_mul_f32 v[176:177], v[176:177], v[60:61]
    v_pk_mul_f32 v[178:179], v[178:179], v[62:63]
    v_cvt_pk_bf16_f32 v46, v176, v177
    v_cvt_pk_bf16_f32 v47, v178, v179
    v_lshlrev_b32 v176, 16, v46
    v_and_b32 v177, 0xffff0000, v46
    v_lshlrev_b32 v178, 16, v47
    v_and_b32 v179, 0xffff0000, v47
    v_pk_mul_f32 v[176:177], v[176:177], v[180:181]
    v_pk_mul_f32 v[178:179], v[178:179], v[182:183]
    v_cvt_pk_bf16_f32 v46, v176, v177
    v_cvt_pk_bf16_f32 v47, v178, v179
    s_nop 0
    v_mov_b32_dpp v36, v46 quad_perm:[0,0,2,2] row_mask:0xf bank_mask:0xf
    v_mov_b32_dpp v37, v47 quad_perm:[0,0,2,2] row_mask:0xf bank_mask:0xf
    v_mov_b32_dpp v38, v46 quad_perm:[1,1,3,3] row_mask:0xf bank_mask:0xf
    v_mov_b32_dpp v39, v47 quad_perm:[1,1,3,3] row_mask:0xf bank_mask:0xf
    s_nop 1
    v_mfma_f32_16x16x32_bf16 v[96:99], v[36:39], a[224:227], 0
    v_mfma_f32_16x16x32_bf16 v[100:103], v[36:39], a[228:231], 0
L_hop_F_10:
    s_cbranch_execz L_hop_F_11
    v_mfma_f32_16x16x32_bf16 v[104:107], v[36:39], a[232:235], 0
    v_mfma_f32_16x16x32_bf16 v[108:111], v[36:39], a[236:239], 0
    v_mfma_f32_16x16x32_bf16 v[112:115], v[36:39], a[240:243], 0
    v_mfma_f32_16x16x32_bf16 v[116:119], v[36:39], a[244:247], 0
    v_mfma_f32_16x16x32_bf16 v[120:123], v[36:39], a[248:251], 0
    v_mfma_f32_16x16x32_bf16 v[124:127], v[36:39], a[252:255], 0
    v_mfma_f32_16x16x32_bf16 v[128:131], v[36:39], v[240:243], 0
    v_mfma_f32_16x16x32_bf16 v[132:135], v[36:39], v[244:247], 0
    v_mfma_f32_16x16x32_bf16 v[136:139], v[36:39], v[248:251], 0
    v_mfma_f32_16x16x32_bf16 v[140:143], v[36:39], v[252:255], 0
    v_cndmask_b32 v52, v96, v100, s[84:85]
    v_cndmask_b32 v52, v52, v104, s[86:87]
    v_cndmask_b32 v52, v52, v108, s[82:83]
    s_nop 1
    v_mov_b32_dpp v24, v52 quad_perm:[0,0,0,0] row_mask:0xf bank_mask:0xf
    v_mov_b32_dpp v25, v52 quad_perm:[1,1,1,1] row_mask:0xf bank_mask:0xf
    v_mov_b32_dpp v26, v52 quad_perm:[2,2,2,2] row_mask:0xf bank_mask:0xf
    v_mov_b32_dpp v27, v52 quad_perm:[3,3,3,3] row_mask:0xf bank_mask:0xf
    v_bfi_b32 v24, v8, s64, v24
    v_bfi_b32 v25, v8, s65, v25
    v_bfi_b32 v26, v8, s66, v26
    v_bfi_b32 v27, v8, s67, v27
    s_mov_b32 exec_lo, 0x11111111
    s_mov_b32 exec_hi, 0x11111111
    buffer_store_dwordx4 v[24:27], v76, s[52:55], s9 offen offset:0 sc1
    s_mov_b64 exec, -1
    v_cndmask_b32 v53, v112, v116, s[84:85]
    v_cndmask_b32 v53, v53, v120, s[86:87]
    v_cndmask_b32 v53, v53, v124, s[82:83]
    s_nop 1
    v_mov_b32_dpp v28, v53 quad_perm:[0,0,0,0] row_mask:0xf bank_mask:0xf
    v_mov_b32_dpp v29, v53 quad_perm:[1,1,1,1] row_mask:0xf bank_mask:0xf
    v_mov_b32_dpp v30, v53 quad_perm:[2,2,2,2] row_mask:0xf bank_mask:0xf
L_hop_F_11:
    s_cbranch_execz L_hop_F_12
    v_mov_b32_dpp v31, v53 quad_perm:[3,3,3,3] row_mask:0xf bank_mask:0xf
    v_bfi_b32 v28, v8, s64, v28
    v_bfi_b32 v29, v8, s65, v29
    v_bfi_b32 v30, v8, s66, v30
    v_bfi_b32 v31, v8, s67, v31
    s_mov_b32 exec_lo, 0x11111111
    s_mov_b32 exec_hi, 0x11111111
    buffer_store_dwordx4 v[28:31], v76, s[52:55], s9 offen offset:1024 sc1
    s_mov_b64 exec, -1
    s_cmp_ge_u32 s3, 2
    s_cbranch_scc1 L_d3
    v_cndmask_b32 v54, v128, v132, s[84:85]
    v_cndmask_b32 v54, v54, v136, s[86:87]
    v_cndmask_b32 v54, v54, v140, s[82:83]
    s_nop 1
    v_mov_b32_dpp v32, v54 quad_perm:[0,0,0,0] row_mask:0xf bank_mask:0xf
    v_mov_b32_dpp v33, v54 quad_perm:[1,1,1,1] row_mask:0xf bank_mask:0xf
    v_mov_b32_dpp v34, v54 quad_perm:[2,2,2,2] row_mask:0xf bank_mask:0xf
    v_mov_b32_dpp v35, v54 quad_perm:[3,3,3,3] row_mask:0xf bank_mask:0xf
    v_bfi_b32 v32, v8, s64, v32
    v_bfi_b32 v33, v8, s65, v33
    v_bfi_b32 v34, v8, s66, v34
    v_bfi_b32 v35, v8, s67, v35
    s_mov_b32 exec_lo, 0x11111111
    s_mov_b32 exec_hi, 0x11111111
    buffer_store_dwordx4 v[32:35], v76, s[52:55], s9 offen offset:2048 sc1
    s_mov_b64 exec, -1
L_d3:
    s_branch L_fin
L_hop_F_12:
    s_cbranch_execz L_hopret_F
L_roleR:
    s_mov_b64 exec, 0
    s_branch L_hop_R_0
L_hopret_R:
    s_mov_b64 exec, -1
    s_lshl2_add_u32 s82, s88, s3
    s_mov_b32 s60, s16
    s_mov_b32 s61, s17
    s_mov_b32 s62, 1280
    s_mov_b32 s63, 0x20000
    s_lshl_b32 s80, s82, 6
    s_lshl_b32 s76, s82, 5
    v_and_b32 v45, 3, v0
    v_lshlrev_b32 v44, 4, v45
    v_lshlrev_b32 v45, 3, v45
    buffer_load_dwordx2 v[68:69], v45, s[60:63], s76 offen
    s_add_u32 s76, s80, 9216
    s_add_u32 s77, s76, 15360
    s_add_u32 s78, s77, 15360
    s_add_u32 s79, s78, 15360
    s_mov_b32 s75, 0
L_poll16:
    buffer_load_dwordx4 v[96:99], v44, s[52:55], s76 offen sc1
    buffer_load_dwordx4 v[100:103], v44, s[52:55], s77 offen sc1
    buffer_load_dwordx4 v[104:107], v44, s[52:55], s78 offen sc1
    buffer_load_dwordx4 v[108:111], v44, s[52:55], s79 offen sc1
    s_add_u32 s75, s75, 1
    s_cmp_gt_u32 s75, 2097152
    s_cbranch_scc1 L_done
    s_waitcnt vmcnt(3)
    v_xor_b32 v96, s64, v96
    v_xor_b32 v97, s65, v97
    v_xor_b32 v98, s66, v98
    v_xor_b32 v99, s67, v99
    v_or3_b32 v46, v96, v97, v98
    v_or_b32 v46, v46, v99
    s_waitcnt vmcnt(2)
    v_xor_b32 v100, s64, v100
    v_xor_b32 v101, s65, v101
    v_xor_b32 v102, s66, v102
    v_xor_b32 v103, s67, v103
    v_or3_b32 v46, v100, v101, v46
    v_or3_b32 v46, v102, v103, v46
    s_waitcnt vmcnt(1)
    v_xor_b32 v104, s64, v104
    v_xor_b32 v105, s65, v105
    v_xor_b32 v106, s66, v106
    v_xor_b32 v107, s67, v107
    v_or3_b32 v46, v104, v105, v46
    v_or3_b32 v46, v106, v107, v46
    s_waitcnt vmcnt(0)
    v_xor_b32 v108, s64, v108
    v_xor_b32 v109, s65, v109
    v_xor_b32 v110, s66, v110
    v_xor_b32 v111, s67, v111
    v_or3_b32 v46, v108, v109, v46
    v_or3_b32 v46, v110, v111, v46
    v_and_b32 v46, v8, v46
    v_cmp_ne_u32 vcc, 0, v46
    s_cbranch_vccnz L_poll16
    v_pk_add_f32 v[96:97], v[96:97], v[100:101]
    v_pk_add_f32 v[98:99], v[98:99], v[102:103]
    v_pk_add_f32 v[104:105], v[104:105], v[108:109]
    v_pk_add_f32 v[106:107], v[106:107], v[110:111]
    v_pk_add_f32 v[52:53], v[96:97], v[104:105]
    v_pk_add_f32 v[54:55], v[98:99], v[106:107]
    v_cvt_pk_bf16_f32 v46, v52, v53
    v_cvt_pk_bf16_f32 v47, v54, v55
    v_lshlrev_b32 v52, 16, v46
    v_and_b32 v53, 0xffff0000, v46
    v_lshlrev_b32 v54, 16, v47
    v_and_b32 v55, 0xffff0000, v47
    s_add_u32 s76, s80, 16896
    s_add_u32 s77, s76, 15360
    s_add_u32 s78, s77, 15360
    s_add_u32 s79, s78, 15360
    s_mov_b32 s75, 0
L_poll17:
    buffer_load_dwordx4 v[96:99], v44, s[52:55], s76 offen sc1
    buffer_load_dwordx4 v[100:103], v44, s[52:55], s77 offen sc1
    buffer_load_dwordx4 v[104:107], v44, s[52:55], s78 offen sc1
    buffer_load_dwordx4 v[108:111], v44, s[52:55], s79 offen sc1
    s_add_u32 s75, s75, 1
    s_cmp_gt_u32 s75, 2097152
    s_cbranch_scc1 L_done
    s_waitcnt vmcnt(3)
    v_xor_b32 v96, s64, v96
    v_xor_b32 v97, s65, v97
    v_xor_b32 v98, s66, v98
    v_xor_b32 v99, s67, v99
    v_or3_b32 v46, v96, v97, v98
    v_or_b32 v46, v46, v99
    s_waitcnt vmcnt(2)
    v_xor_b32 v100, s64, v100
    v_xor_b32 v101, s65, v101
    v_xor_b32 v102, s66, v102
    v_xor_b32 v103, s67, v103
    v_or3_b32 v46, v100, v101, v46
    v_or3_b32 v46, v102, v103, v46
    s_waitcnt vmcnt(1)
    v_xor_b32 v104, s64, v104
    v_xor_b32 v105, s65, v105
    v_xor_b32 v106, s66, v106
    v_xor_b32 v107, s67, v107
    v_or3_b32 v46, v104, v105, v46
    v_or3_b32 v46, v106, v107, v46
    s_waitcnt vmcnt(0)
    v_xor_b32 v108, s64, v108
    v_xor_b32 v109, s65, v109
    v_xor_b32 v110, s66, v110
    v_xor_b32 v111, s67, v111
    v_or3_b32 v46, v108, v109, v46
    v_or3_b32 v46, v110, v111, v46
    v_and_b32 v46, v8, v46
    v_cmp_ne_u32 vcc, 0, v46
    s_cbranch_vccnz L_poll17
    v_pk_add_f32 v[96:97], v[96:97], v[100:101]
    v_pk_add_f32 v[98:99], v[98:99], v[102:103]
    v_pk_add_f32 v[104:105], v[104:105], v[108:109]
    v_pk_add_f32 v[106:107], v[106:107], v[110:111]
    v_pk_add_f32 v[56:57], v[96:97], v[104:105]
    v_pk_add_f32 v[58:59], v[98:99], v[106:107]
    v_cvt_pk_bf16_f32 v46, v56, v57
    v_cvt_pk_bf16_f32 v47, v58, v59
    v_lshlrev_b32 v56, 16, v46
    v_and_b32 v57, 0xffff0000, v46
    v_lshlrev_b32 v58, 16, v47
    v_and_b32 v59, 0xffff0000, v47
    v_lshlrev_b32 v64, 16, v68
    v_and_b32 v65, 0xffff0000, v68
    v_lshlrev_b32 v66, 16, v69
    v_and_b32 v67, 0xffff0000, v69
L_hop_R_0:
    s_cbranch_execz L_hop_R_1
    s_add_u32 s16, s80, 655360
    s_add_u32 s17, s80, 660480
    s_add_u32 s18, s80, 665600
    s_add_u32 s19, s80, 670720
    s_add_u32 s20, s80, 675840
    s_add_u32 s21, s80, 680960
    s_mov_b32 s75, 0
L_poll18:
    buffer_load_dwordx4 v[96:99], v44, s[52:55], s16 offen offset:0 sc1
    buffer_load_dwordx4 v[100:103], v44, s[52:55], s16 offen offset:2560 sc1
L_hop_R_1:
    s_cbranch_execz L_hop_R_2
    buffer_load_dwordx4 v[104:107], v44, s[52:55], s17 offen offset:0 sc1
    buffer_load_dwordx4 v[108:111], v44, s[52:55], s17 offen offset:2560 sc1
    buffer_load_dwordx4 v[112:115], v44, s[52:55], s18 offen offset:0 sc1
    buffer_load_dwordx4 v[116:119], v44, s[52:55], s18 offen offset:2560 sc1
    buffer_load_dwordx4 v[120:123], v44, s[52:55], s19 offen offset:0 sc1
    buffer_load_dwordx4 v[124:127], v44, s[52:55], s19 offen offset:2560 sc1
    buffer_load_dwordx4 v[128:131], v44, s[52:55], s20 offen offset:0 sc1
    buffer_load_dwordx4 v[132:135], v44, s[52:55], s20 offen offset:2560 sc1
    buffer_load_dwordx4 v[136:139], v44, s[52:55], s21 offen offset:0 sc1
    s_add_u32 s75, s75, 1
    s_cmp_gt_u32 s75, 2097152
    s_cbranch_scc1 L_done
    s_waitcnt vmcnt(10)
    v_xor_b32 v96, s64, v96
    v_xor_b32 v97, s65, v97
    v_xor_b32 v98, s66, v98
    v_xor_b32 v99, s67, v99
    v_or3_b32 v46, v96, v97, v98
    v_or_b32 v46, v46, v99
    s_waitcnt vmcnt(9)
    v_xor_b32 v100, s64, v100
    v_xor_b32 v101, s65, v101
    v_xor_b32 v102, s66, v102
    v_xor_b32 v103, s67, v103
    v_or3_b32 v46, v100, v101, v46
    v_or3_b32 v46, v102, v103, v46
    s_waitcnt vmcnt(8)
    v_xor_b32 v104, s64, v104
    v_xor_b32 v105, s65, v105
    v_xor_b32 v106, s66, v106
    v_xor_b32 v107, s67, v107
    v_or3_b32 v46, v104, v105, v46
    v_or3_b32 v46, v106, v107, v46
    s_waitcnt vmcnt(7)
    v_xor_b32 v108, s64, v108
    v_xor_b32 v109, s65, v109
    v_xor_b32 v110, s66, v110
    v_xor_b32 v111, s67, v111
    v_or3_b32 v46, v108, v109, v46
    v_or3_b32 v46, v110, v111, v46
    s_waitcnt vmcnt(6)
    v_xor_b32 v112, s64, v112
    v_xor_b32 v113, s65, v113
    v_xor_b32 v114, s66, v114
    v_xor_b32 v115, s67, v115
    v_or3_b32 v46, v112, v113, v46
L_hop_R_2:
    s_cbranch_execz L_hop_R_3
    v_or3_b32 v46, v114, v115, v46
    s_waitcnt vmcnt(5)
    v_xor_b32 v116, s64, v116
    v_xor_b32 v117, s65, v117
    v_xor_b32 v118, s66, v118
    v_xor_b32 v119, s67, v119
    v_or3_b32 v46, v116, v117, v46
    v_or3_b32 v46, v118, v119, v46
    s_waitcnt vmcnt(4)
    v_xor_b32 v120, s64, v120
    v_xor_b32 v121, s65, v121
    v_xor_b32 v122, s66, v122
    v_xor_b32 v123, s67, v123
    v_or3_b32 v46, v120, v121, v46
    v_or3_b32 v46, v122, v123, v46
    s_waitcnt vmcnt(3)
    v_xor_b32 v124, s64, v124
    v_xor_b32 v125, s65, v125
    v_xor_b32 v126, s66, v126
    v_xor_b32 v127, s67, v127
    v_or3_b32 v46, v124, v125, v46
    v_or3_b32 v46, v126, v127, v46
    s_waitcnt vmcnt(2)
    v_xor_b32 v128, s64, v128
    v_xor_b32 v129, s65, v129
    v_xor_b32 v130, s66, v130
    v_xor_b32 v131, s67, v131
    v_or3_b32 v46, v128, v129, v46
    v_or3_b32 v46, v130, v131, v46
    s_waitcnt vmcnt(1)
    v_xor_b32 v132, s64, v132
    v_xor_b32 v133, s65, v133
    v_xor_b32 v134, s66, v134
    v_xor_b32 v135, s67, v135
    v_or3_b32 v46, v132, v133, v46
    v_or3_b32 v46, v134, v135, v46
    s_waitcnt vmcnt(0)
    v_xor_b32 v136, s64, v136
    v_xor_b32 v137, s65, v137
    v_xor_b32 v138, s66, v138
    v_xor_b32 v139, s67, v139
    v_or3_b32 v46, v136, v137, v46
    v_or3_b32 v46, v138, v139, v46
    v_and_b32 v46, v8, v46
    v_cmp_ne_u32 vcc, 0, v46
    s_cbranch_vccnz L_poll18
    v_pk_add_f32 v[96:97], v[96:97], v[100:101]
    v_pk_add_f32 v[98:99], v[98:99], v[102:103]
L_hop_R_3:
    s_cbranch_execz L_hop_R_4
    v_pk_add_f32 v[104:105], v[104:105], v[108:109]
    v_pk_add_f32 v[106:107], v[106:107], v[110:111]
    v_pk_add_f32 v[112:113], v[112:113], v[116:117]
    v_pk_add_f32 v[114:115], v[114:115], v[118:119]
    v_pk_add_f32 v[120:121], v[120:121], v[124:125]
    v_pk_add_f32 v[122:123], v[122:123], v[126:127]
    v_pk_add_f32 v[128:129], v[128:129], v[132:133]
    v_pk_add_f32 v[130:131], v[130:131], v[134:135]
    v_pk_add_f32 v[96:97], v[96:97], v[104:105]
    v_pk_add_f32 v[98:99], v[98:99], v[106:107]
    v_pk_add_f32 v[112:113], v[112:113], v[120:121]
    v_pk_add_f32 v[114:115], v[114:115], v[122:123]
    v_pk_add_f32 v[128:129], v[128:129], v[136:137]
    v_pk_add_f32 v[130:131], v[130:131], v[138:139]
    v_pk_add_f32 v[96:97], v[96:97], v[112:113]
    v_pk_add_f32 v[98:99], v[98:99], v[114:115]
    v_pk_add_f32 v[68:69], v[96:97], v[128:129]
    v_pk_add_f32 v[70:71], v[98:99], v[130:131]
    v_cvt_pk_bf16_f32 v46, v68, v69
    v_cvt_pk_bf16_f32 v47, v70, v71
    v_lshlrev_b32 v68, 16, v46
    v_and_b32 v69, 0xffff0000, v46
    v_lshlrev_b32 v70, 16, v47
    v_and_b32 v71, 0xffff0000, v47
    v_pk_mul_f32 v[68:69], v[68:69], v[52:53]
    v_pk_mul_f32 v[70:71], v[70:71], v[54:55]
    v_cvt_pk_bf16_f32 v46, v68, v69
    v_cvt_pk_bf16_f32 v47, v70, v71
    v_lshlrev_b32 v68, 16, v46
    v_and_b32 v69, 0xffff0000, v46
    v_lshlrev_b32 v70, 16, v47
    v_and_b32 v71, 0xffff0000, v47
    v_pk_add_f32 v[64:65], v[64:65], v[68:69]
L_hop_R_4:
    s_cbranch_execz L_hop_R_5
    v_pk_add_f32 v[66:67], v[66:67], v[70:71]
    v_cvt_pk_bf16_f32 v46, v64, v65
    v_cvt_pk_bf16_f32 v47, v66, v67
    v_lshlrev_b32 v64, 16, v46
    v_and_b32 v65, 0xffff0000, v46
    v_lshlrev_b32 v66, 16, v47
    v_and_b32 v67, 0xffff0000, v47
    v_lshrrev_b32 v47, 2, v0
    v_mul_u32_u24 v47, 2560, v47
    v_add_u32 v47, v47, v44
    s_add_u32 s76, s80, 720896
    s_add_u32 s77, s76, 40960
    s_add_u32 s78, s77, 40960
    s_mov_b32 s56, s38
    s_mov_b32 s57, s39
    s_mov_b32 s58, 1280
    s_mov_b32 s59, 0x20000
    s_lshl_b32 s79, s82, 5
    s_mov_b32 s75, 0
L_poll19:
    buffer_load_dwordx4 v[96:99], v47, s[52:55], s76 offen sc1
    buffer_load_dwordx4 v[100:103], v47, s[52:55], s77 offen sc1
    buffer_load_dwordx4 v[104:107], v47, s[52:55], s78 offen sc1
    s_add_u32 s75, s75, 1
    s_cmp_gt_u32 s75, 2097152
    s_cbranch_scc1 L_done
    s_waitcnt vmcnt(2)
    v_xor_b32 v96, s64, v96
    v_xor_b32 v97, s65, v97
    v_xor_b32 v98, s66, v98
    v_xor_b32 v99, s67, v99
    v_or3_b32 v46, v96, v97, v98
    v_or_b32 v46, v46, v99
    s_waitcnt vmcnt(1)
    v_xor_b32 v100, s64, v100
    v_xor_b32 v101, s65, v101
    v_xor_b32 v102, s66, v102
    v_xor_b32 v103, s67, v103
    v_or3_b32 v46, v100, v101, v46
    v_or3_b32 v46, v102, v103, v46
    s_waitcnt vmcnt(0)
    v_xor_b32 v104, s64, v104
    v_xor_b32 v105, s65, v105
    v_xor_b32 v106, s66, v106
    v_xor_b32 v107, s67, v107
    v_or3_b32 v46, v104, v105, v46
L_hop_R_5:
    s_cbranch_execz L_hop_R_6
    v_or3_b32 v46, v106, v107, v46
    v_and_b32 v46, v8, v46
    v_cmp_ne_u32 vcc, 0, v46
    s_cbranch_vccnz L_poll19
    v_pk_add_f32 v[96:97], v[96:97], v[100:101]
    v_pk_add_f32 v[98:99], v[98:99], v[102:103]
    v_pk_add_f32 v[68:69], v[96:97], v[104:105]
    v_pk_add_f32 v[70:71], v[98:99], v[106:107]
    s_nop 0
    v_add_f32_dpp v68, v68, v68 row_ror:4 row_mask:0xf bank_mask:0xf
    v_add_f32_dpp v69, v69, v69 row_ror:4 row_mask:0xf bank_mask:0xf
    v_add_f32_dpp v70, v70, v70 row_ror:4 row_mask:0xf bank_mask:0xf
    v_add_f32_dpp v71, v71, v71 row_ror:4 row_mask:0xf bank_mask:0xf
    v_add_f32_dpp v68, v68, v68 row_ror:8 row_mask:0xf bank_mask:0xf
    v_add_f32_dpp v69, v69, v69 row_ror:8 row_mask:0xf bank_mask:0xf
    v_add_f32_dpp v70, v70, v70 row_ror:8 row_mask:0xf bank_mask:0xf
    v_add_f32_dpp v71, v71, v71 row_ror:8 row_mask:0xf bank_mask:0xf
    v_mov_b32 v60, v68
    v_mov_b32 v61, v69
    v_mov_b32 v62, v70
    v_mov_b32 v63, v71
    v_permlane16_swap_b32 v68, v60
    v_permlane16_swap_b32 v69, v61
    v_permlane16_swap_b32 v70, v62
    v_permlane16_swap_b32 v71, v63
    v_add_f32 v68, v68, v60
    v_add_f32 v69, v69, v61
    v_add_f32 v70, v70, v62
    v_add_f32 v71, v71, v63
    v_mov_b32 v60, v68
    v_mov_b32 v61, v69
    v_mov_b32 v62, v70
    v_mov_b32 v63, v71
    v_permlane32_swap_b32 v68, v60
    v_permlane32_swap_b32 v69, v61
    v_permlane32_swap_b32 v70, v62
    v_permlane32_swap_b32 v71, v63
    v_add_f32 v68, v68, v60
    v_add_f32 v69, v69, v61
    v_add_f32 v70, v70, v62
    v_add_f32 v71, v71, v63
    v_cvt_pk_bf16_f32 v46, v68, v69
    v_cvt_pk_bf16_f32 v47, v70, v71
    v_lshlrev_b32 v68, 16, v46
    v_and_b32 v69, 0xffff0000, v46
    v_lshlrev_b32 v70, 16, v47
L_hop_R_6:
    s_cbranch_execz L_hop_R_7
    v_and_b32 v71, 0xffff0000, v47
    v_pk_mul_f32 v[68:69], v[68:69], v[56:57]
    v_pk_mul_f32 v[70:71], v[70:71], v[58:59]
    v_cvt_pk_bf16_f32 v46, v68, v69
    v_cvt_pk_bf16_f32 v47, v70, v71
    v_lshlrev_b32 v68, 16, v46
    v_and_b32 v69, 0xffff0000, v46
    v_lshlrev_b32 v70, 16, v47
    v_and_b32 v71, 0xffff0000, v47
    v_pk_add_f32 v[64:65], v[64:65], v[68:69]
    v_pk_add_f32 v[66:67], v[66:67], v[70:71]
    v_cvt_pk_bf16_f32 v48, v64, v65
    v_cvt_pk_bf16_f32 v49, v66, v67
    s_mov_b64 exec, 15
    buffer_store_dwordx2 v[48:49], v45, s[56:59], s79 offen
    s_cmp_lg_u32 s82, 0
    s_cbranch_scc1 L_noepoch
    v_mov_b32 v50, s94
    v_mov_b32 v51, 0
    s_mov_b64 exec, 1
    buffer_store_dword v50, v51, s[52:55], 0 offen offset:0 sc1
L_noepoch:
    s_mov_b64 exec, -1
L_fin:
L_done:
    s_endpgm
L_hop_R_7:
    s_cbranch_execz L_hopret_R
    s_endpgm
.section .rodata,"a"
.p2align 6
.amdhsa_kernel adaLN_cond__mha_block_cached__glu_gated_geglu__decode_kernel
.amdhsa_next_free_vgpr 512
.amdhsa_next_free_sgpr 102
.amdhsa_accum_offset 256
.amdhsa_group_segment_fixed_size 0
.amdhsa_kernarg_size 112
.amdhsa_user_sgpr_count 2
.amdhsa_user_sgpr_kernarg_segment_ptr 1
.amdhsa_system_sgpr_workgroup_id_x 1
.amdhsa_float_denorm_mode_32 3
.end_amdhsa_kernel
```
